```python
import torch

def _softmax(x, axis=-1):
    return torch.softmax(x, dim=axis)
def _gelu(x):
    return torch.nn.functional.gelu(x, approximate="tanh")
def _silu(x):
    return torch.nn.functional.silu(x)
def _sigmoid(x):
    return torch.sigmoid(x)
def _layernorm(x, axis=-1, eps=1e-5):
    m = x.mean(dim=axis, keepdim=True)
    v = x.var(dim=axis, keepdim=True, unbiased=False)
    return (x - m) / torch.sqrt(v + eps)
def _scatter_add(tgt, idx, src, axis=0):
    return tgt.clone().index_add_(axis, idx, src)
def _segment_sum(src, seg, n):
    out = torch.zeros((n,) + src.shape[1:], dtype=src.dtype)
    return out.index_add_(0, seg, src)
def _pad(x, pw):
    flat = tuple(v for pair in reversed(pw) for v in pair)
    return torch.nn.functional.pad(x, flat)

kernel_name = 'recurrent_scan__mha_block_cached__dense_activation_gelu__decode'

def setup_inputs():

    _w = (lambda a: (lambda t: t.to(torch.bfloat16) if t.is_floating_point() else t)(torch.as_tensor(a)))
    def _A_setup():
        B, Sq, D = 8, 1, 576
        H, Sk, Dh = 32, 4096, 128
        return {
            "x": _w((lambda *s: torch.randn(*s, dtype=torch.bfloat16) * 0.05)(B, Sq, D)),
            "k_cache": _w((lambda *s: torch.randn(*s, dtype=torch.bfloat16) * 3.2)(B, H, Sk, Dh)),
            "v_cache": _w((lambda *s: torch.randn(*s, dtype=torch.bfloat16) * 3.2)(B, H, Sk, Dh)),
            "wq": _w((lambda *s: torch.randn(*s, dtype=torch.bfloat16) * 3.2)(D, H * Dh) * (D ** -0.5)),
            "wo": _w((lambda *s: torch.randn(*s, dtype=torch.bfloat16) * 3.2)(H * Dh, D) * ((H * Dh) ** -0.5)),
        }
    _A_in = _A_setup()

    def _B_setup():
        B, S, D, F = 8, 1, 576, 4608
        return {
            "x": _w((lambda *s: torch.randn(*s, dtype=torch.bfloat16) * 0.05)(B, S, D)),
            "w1": _w((lambda *s: torch.randn(*s, dtype=torch.bfloat16) * 3.2)(D, F) * (D ** -0.5)),
            "b1": _w((lambda *s: torch.randn(*s, dtype=torch.bfloat16) * 3.2)(F) * 0.01),
            "w2": _w((lambda *s: torch.randn(*s, dtype=torch.bfloat16) * 0.4)(F, D) * (F ** -0.5)),
            "b2": _w((lambda *s: torch.randn(*s, dtype=torch.bfloat16) * 0.4)(D) * 0.01),
        }
    _B_in = _B_setup()

    return {
        "A_x": _A_in["x"],
        "A_k_cache": _A_in["k_cache"],
        "A_v_cache": _A_in["v_cache"],
        "A_wq": _A_in["wq"],
        "A_wo": _A_in["wo"],
        "B_x": _B_in["x"],
        "B_w1": _B_in["w1"],
        "B_b1": _B_in["b1"],
        "B_w2": _B_in["w2"],
        "B_b2": _B_in["b2"],
    }

def reference(A_x, A_k_cache, A_v_cache, A_wq, A_wo, B_x, B_w1, B_b1, B_w2, B_b2):
    def _A_ref(x, k_cache, v_cache, wq, wo):
        B, Sq, D = x.shape
        H, Dh = 32, 128
        q = (lambda x, *d: x.permute(*d))((x @ wq).reshape(B, Sq, H, Dh), 0, 2, 1, 3)
        scores = torch.einsum("bhqd,bhkd->bhqk", q, k_cache) * (Dh ** -0.5)
        p = _softmax(scores, axis=-1)
        o = torch.einsum("bhqk,bhkd->bhqd", p, v_cache)
        return (lambda x, *d: x.permute(*d))(o, 0, 2, 1, 3).reshape(B, Sq, H * Dh) @ wo

    def _B_ref(x, w1, b1, w2, b2):
        h = torch.einsum("bsd,df->bsf", x, w1) + b1
        h = _gelu(h)
        return torch.einsum("bsf,fd->bsd", h, w2) + b2

    x = A_x
    xn = _layernorm(x, axis=-1)
    s = _A_ref(xn, A_k_cache, A_v_cache, A_wq, A_wo)
    g = _silu(_B_ref(xn, B_w1, B_b1, B_w2, B_b2))
    return x + s * g
```

```asm
; @launch grid=(256,1,1) block=(512,1,1) lds=143360
.amdgcn_target "amdgcn-amd-amdhsa--gfx950"
.text
.globl recurrent_scan__mha_block_cached__dense_activation_gelu__decode_kernel
.p2align 8
.type recurrent_scan__mha_block_cached__dense_activation_gelu__decode_kernel,@function
recurrent_scan__mha_block_cached__dense_activation_gelu__decode_kernel:
  s_cmp_ge_u32 s2, 256
  s_cbranch_scc1 L_end
  s_load_dwordx16 s[36:51], s[0:1], 0
  s_load_dwordx8 s[52:59], s[0:1], 64
  s_load_dwordx2 s[60:61], s[0:1], 96
  s_getpc_b64 s[34:35]
L_pc:
  s_bfe_u32 s33, s2, 0x40003
  s_lshl_b32 s3, s33, 11
  v_lshl_add_u32 v10, v0, 2, s3
  v_min_u32 v10, L_code_end-L_pc-4, v10
  v_mov_b32 v11, s35
  v_add_co_u32 v10, vcc, s34, v10
  v_lshrrev_b32 v1, 6, v0
  s_and_b32 s3, s2, 0x80
  v_addc_co_u32 v11, vcc, 0, v11, vcc
  global_load_dword v255, v[10:11], off
  v_readfirstlane_b32 s28, v1
  s_or_b32 s33, s33, s3
  s_and_b32 s3, s2, 7
  s_lshl_b32 s3, s3, 4
  s_or_b32 s33, s33, s3
  s_mulk_i32 s33, 18432
  v_mul_u32_u24 v180, 3584, v1
  v_lshl_add_u32 v180, v0, 4, v180
  s_movk_i32 s10, 18432
  s_mov_b32 s11, 0x20000
  s_cmp_ge_u32 s28, 4
  s_waitcnt lgkmcnt(0)
  s_cbranch_scc1 L_helper
  s_add_u32 s8, s44, s33
  s_addc_u32 s9, s45, 0
  buffer_load_dwordx4 v[112:115], v180, s[8:11], 0 offen offset:0
  buffer_load_dwordx4 v[116:119], v180, s[8:11], 0 offen offset:1024
  buffer_load_dwordx4 v[120:123], v180, s[8:11], 0 offen offset:2048
  buffer_load_dwordx4 v[124:127], v180, s[8:11], 0 offen offset:3072
  buffer_load_dwordx4 v[128:131], v180, s[8:11], 0 offen offset:3584
  s_branch L_streamer
L_helper:
  s_setprio 1
  v_and_b32 v64, 31, v0
  v_mul_u32_u24 v64, 36, v64
  s_lshr_b32 s30, s2, 5
  s_mul_i32 s68, s30, 1152
  s_mov_b32 s8, s36
  s_mov_b32 s9, s37
  s_mov_b32 s10, 9216
  s_mov_b32 s11, 0x20000
  buffer_load_dwordx4 v[52:55], v64, s[8:11], s68 offen
  buffer_load_dwordx4 v[56:59], v64, s[8:11], s68 offen offset:16
  buffer_load_dword v60, v64, s[8:11], s68 offen offset:32
  v_and_b32 v2, 63, v0
  v_mov_b32 v6, 131072
  v_mov_b32 v8, 0
  v_mov_b32 v9, 0
  v_lshl_add_u32 v7, v0, 3, v6
  ds_write_b64 v7, v[8:9] offset:8192
  v_and_b32 v4, 15, v2
  v_lshl_add_u32 v7, v4, 2, v6
  ds_write_b32 v7, v8 offset:6208
  s_and_b32 s78, s2, 240
  s_bfe_u32 s3, s2, 196608
  s_lshl_b32 s3, s3, 1
  s_or_b32 s78, s78, s3
  s_bfe_u32 s3, s2, 65539
  s_or_b32 s78, s78, s3
  s_mov_b32 s69, 0x200000
  s_waitcnt lgkmcnt(0)
  s_barrier
  s_sub_u32 s28, s28, 4
  s_and_b32 s29, s78, 31
  v_lshrrev_b32 v5, 4, v2
  s_mul_i32 s3, s28, 144
  v_lshl_add_u32 v65, v5, 2, s3
  v_lshlrev_b32 v66, 13, v65
  v_lshl_add_u32 v66, v4, 4, v66
  s_lshl_b32 s3, s29, 8
  s_add_u32 s12, s42, s3
  s_addc_u32 s13, s43, 0
  s_mov_b32 s14, 4710656
  s_mov_b32 s15, 0x20000
  s_and_b32 s3, s2, 40
  s_cmp_lg_u32 s3, 0
  s_cbranch_scc1 L_h_nomark
  s_bfe_u32 s3, s2, 196608
  s_bfe_u32 s35, s2, 65540
  s_lshl_b32 s35, s35, 3
  s_or_b32 s3, s3, s35
  s_bfe_u32 s35, s2, 131078
  s_lshl_b32 s35, s35, 4
  s_or_b32 s3, s3, s35
  s_mul_i32 s3, s3, 18432
  s_add_u32 s20, s60, s3
  s_addc_u32 s21, s61, 0
  s_mov_b32 s22, 18432
  s_mov_b32 s23, 0x20000
  v_mov_b32 v48, -1
  v_mov_b32 v49, -1
  v_mov_b32 v50, -1
  v_mov_b32 v51, -1
  v_subrev_u32 v69, 256, v0
  v_lshlrev_b32 v69, 4, v69
  s_mov_b32 s35, 0
  buffer_store_dwordx4 v[48:51], v69, s[20:23], s35 offen sc1
  s_add_u32 s35, s35, 4096
  buffer_store_dwordx4 v[48:51], v69, s[20:23], s35 offen sc1
  s_add_u32 s35, s35, 4096
  buffer_store_dwordx4 v[48:51], v69, s[20:23], s35 offen sc1
  s_add_u32 s35, s35, 4096
  buffer_store_dwordx4 v[48:51], v69, s[20:23], s35 offen sc1
  s_add_u32 s35, s35, 4096
  buffer_store_dwordx4 v[48:51], v69, s[20:23], s35 offen sc1
  s_add_u32 s35, s35, 4096
L_h_nomark:
  s_mov_b32 s32, s30
  s_mov_b32 s33, s32
  s_lshl_b32 s34, s33, 17
  buffer_load_dwordx4 v[112:115], v66, s[12:15], s34 offen
  s_add_u32 s34, s34, 8192
  buffer_load_dwordx4 v[116:119], v66, s[12:15], s34 offen
  s_add_u32 s34, s34, 8192
  buffer_load_dwordx4 v[120:123], v66, s[12:15], s34 offen
  s_add_u32 s34, s34, 8192
  buffer_load_dwordx4 v[124:127], v66, s[12:15], s34 offen
  s_add_u32 s34, s34, 8192
  s_add_u32 s33, s33, 1
  s_cmp_eq_u32 s33, 9
  s_cselect_b32 s33, 0, s33
  s_waitcnt vmcnt(4)
L_h_ln:
  s_mov_b32 s94, 0x05040100
  s_mov_b32 s95, 0x07060302
  v_lshlrev_b32 v16, 16, v52
  v_and_b32 v17, 0xffff0000, v52
  v_lshlrev_b32 v18, 16, v53
  v_and_b32 v19, 0xffff0000, v53
  v_lshlrev_b32 v20, 16, v54
  v_and_b32 v21, 0xffff0000, v54
  v_lshlrev_b32 v22, 16, v55
  v_and_b32 v23, 0xffff0000, v55
  v_lshlrev_b32 v24, 16, v56
  v_and_b32 v25, 0xffff0000, v56
  v_lshlrev_b32 v26, 16, v57
  v_and_b32 v27, 0xffff0000, v57
  v_lshlrev_b32 v28, 16, v58
  v_and_b32 v29, 0xffff0000, v58
  v_lshlrev_b32 v30, 16, v59
  v_and_b32 v31, 0xffff0000, v59
  v_lshlrev_b32 v32, 16, v60
  v_and_b32 v33, 0xffff0000, v60
  v_add_f32 v34, v16, v17
  v_add_f32 v34, v34, v18
  v_add_f32 v34, v34, v19
  v_add_f32 v34, v34, v20
  v_add_f32 v34, v34, v21
  v_add_f32 v34, v34, v22
  v_add_f32 v34, v34, v23
  v_add_f32 v34, v34, v24
  v_add_f32 v34, v34, v25
  v_add_f32 v34, v34, v26
  v_add_f32 v34, v34, v27
  v_add_f32 v34, v34, v28
  v_add_f32 v34, v34, v29
  v_add_f32 v34, v34, v30
  v_add_f32 v34, v34, v31
  v_add_f32 v34, v34, v32
  v_add_f32 v34, v34, v33
  s_nop 1
  v_add_f32_dpp v34, v34, v34 row_ror:8 row_mask:0xf bank_mask:0xf
  s_nop 1
  v_add_f32_dpp v34, v34, v34 row_ror:4 row_mask:0xf bank_mask:0xf
  s_nop 1
  v_add_f32_dpp v34, v34, v34 row_ror:2 row_mask:0xf bank_mask:0xf
  s_nop 1
  v_add_f32_dpp v34, v34, v34 row_ror:1 row_mask:0xf bank_mask:0xf
  v_mov_b32 v35, v34
  s_nop 1
  v_permlane16_swap_b32 v35, v34
  s_lshl_b32 s34, s33, 17
  s_waitcnt vmcnt(3)
  buffer_load_dwordx4 v[128:131], v66, s[12:15], s34 offen
  s_add_u32 s34, s34, 8192
  s_nop 1
  v_add_f32 v34, v34, v35
  v_mul_f32 v36, 0x3ae38e39, v34
  v_mov_b32 v34, 0
  v_sub_f32 v38, v16, v36
  v_fmac_f32 v34, v38, v38
  v_sub_f32 v39, v17, v36
  v_fmac_f32 v34, v39, v39
  v_sub_f32 v38, v18, v36
  v_fmac_f32 v34, v38, v38
  v_sub_f32 v39, v19, v36
  v_fmac_f32 v34, v39, v39
  v_sub_f32 v38, v20, v36
  v_fmac_f32 v34, v38, v38
  v_sub_f32 v39, v21, v36
  v_fmac_f32 v34, v39, v39
  v_sub_f32 v38, v22, v36
  v_fmac_f32 v34, v38, v38
  v_sub_f32 v39, v23, v36
  v_fmac_f32 v34, v39, v39
  v_sub_f32 v38, v24, v36
  v_fmac_f32 v34, v38, v38
  v_sub_f32 v39, v25, v36
  v_fmac_f32 v34, v39, v39
  v_sub_f32 v38, v26, v36
  v_fmac_f32 v34, v38, v38
  v_sub_f32 v39, v27, v36
  v_fmac_f32 v34, v39, v39
  v_sub_f32 v38, v28, v36
  v_fmac_f32 v34, v38, v38
  v_sub_f32 v39, v29, v36
  v_fmac_f32 v34, v39, v39
  v_sub_f32 v38, v30, v36
  v_fmac_f32 v34, v38, v38
  v_sub_f32 v39, v31, v36
  v_fmac_f32 v34, v39, v39
  v_sub_f32 v38, v32, v36
  v_fmac_f32 v34, v38, v38
  v_sub_f32 v39, v33, v36
  v_fmac_f32 v34, v39, v39
  s_nop 1
  v_add_f32_dpp v34, v34, v34 row_ror:8 row_mask:0xf bank_mask:0xf
  s_nop 1
  v_add_f32_dpp v34, v34, v34 row_ror:4 row_mask:0xf bank_mask:0xf
  s_nop 1
  v_add_f32_dpp v34, v34, v34 row_ror:2 row_mask:0xf bank_mask:0xf
  s_nop 1
  v_add_f32_dpp v34, v34, v34 row_ror:1 row_mask:0xf bank_mask:0xf
  v_mov_b32 v35, v34
  s_waitcnt vmcnt(3)
  buffer_load_dwordx4 v[132:135], v66, s[12:15], s34 offen
  s_add_u32 s34, s34, 8192
  s_nop 1
  v_permlane16_swap_b32 v35, v34
  s_nop 1
  v_add_f32 v34, v34, v35
  v_mul_f32 v34, 0x3ae38e39, v34
  v_cvt_pk_bf16_f32 v36, v36, v36
  v_and_b32 v36, 0xffff0000, v36
  v_cvt_pk_bf16_f32 v34, v34, v34
  v_and_b32 v34, 0xffff0000, v34
  v_add_f32 v34, 0x37280000, v34
  v_cvt_pk_bf16_f32 v34, v34, v34
  v_and_b32 v34, 0xffff0000, v34
  v_sqrt_f32 v34, v34
  s_nop 0
  v_cvt_pk_bf16_f32 v34, v34, v34
  v_and_b32 v34, 0xffff0000, v34
  v_rcp_f32 v34, v34
  v_sub_f32 v16, v16, v36
  v_sub_f32 v17, v17, v36
  v_sub_f32 v18, v18, v36
  v_sub_f32 v19, v19, v36
  v_sub_f32 v20, v20, v36
  v_sub_f32 v21, v21, v36
  v_sub_f32 v22, v22, v36
  v_sub_f32 v23, v23, v36
  v_sub_f32 v24, v24, v36
  v_sub_f32 v25, v25, v36
  v_sub_f32 v26, v26, v36
  v_sub_f32 v27, v27, v36
  v_sub_f32 v28, v28, v36
  v_sub_f32 v29, v29, v36
  v_sub_f32 v30, v30, v36
  v_sub_f32 v31, v31, v36
  v_sub_f32 v32, v32, v36
  v_sub_f32 v33, v33, v36
  v_cvt_pk_bf16_f32 v52, v16, v17
  v_cvt_pk_bf16_f32 v53, v18, v19
  v_cvt_pk_bf16_f32 v54, v20, v21
  v_cvt_pk_bf16_f32 v55, v22, v23
  v_cvt_pk_bf16_f32 v56, v24, v25
  v_cvt_pk_bf16_f32 v57, v26, v27
  v_cvt_pk_bf16_f32 v58, v28, v29
  v_cvt_pk_bf16_f32 v59, v30, v31
  v_cvt_pk_bf16_f32 v60, v32, v33
  v_lshlrev_b32 v16, 16, v52
  v_and_b32 v17, 0xffff0000, v52
  v_lshlrev_b32 v18, 16, v53
  v_and_b32 v19, 0xffff0000, v53
  v_lshlrev_b32 v20, 16, v54
  s_waitcnt vmcnt(3)
  buffer_load_dwordx4 v[136:139], v66, s[12:15], s34 offen
  s_add_u32 s34, s34, 8192
  v_and_b32 v21, 0xffff0000, v54
  v_lshlrev_b32 v22, 16, v55
  v_and_b32 v23, 0xffff0000, v55
  v_lshlrev_b32 v24, 16, v56
  v_and_b32 v25, 0xffff0000, v56
  v_lshlrev_b32 v26, 16, v57
  v_and_b32 v27, 0xffff0000, v57
  v_lshlrev_b32 v28, 16, v58
  v_and_b32 v29, 0xffff0000, v58
  v_lshlrev_b32 v30, 16, v59
  v_and_b32 v31, 0xffff0000, v59
  v_lshlrev_b32 v32, 16, v60
  v_and_b32 v33, 0xffff0000, v60
  v_mul_f32 v16, v16, v34
  v_mul_f32 v17, v17, v34
  v_mul_f32 v18, v18, v34
  v_mul_f32 v19, v19, v34
  v_mul_f32 v20, v20, v34
  v_mul_f32 v21, v21, v34
  v_mul_f32 v22, v22, v34
  v_mul_f32 v23, v23, v34
  v_mul_f32 v24, v24, v34
  v_mul_f32 v25, v25, v34
  v_mul_f32 v26, v26, v34
  v_mul_f32 v27, v27, v34
  v_mul_f32 v28, v28, v34
  v_mul_f32 v29, v29, v34
  v_mul_f32 v30, v30, v34
  v_mul_f32 v31, v31, v34
  v_mul_f32 v32, v32, v34
  v_mul_f32 v33, v33, v34
  v_cvt_pk_bf16_f32 v16, v16, v16
  v_cvt_pk_bf16_f32 v17, v17, v17
  v_cvt_pk_bf16_f32 v18, v18, v18
  v_cvt_pk_bf16_f32 v19, v19, v19
  v_cvt_pk_bf16_f32 v20, v20, v20
  v_cvt_pk_bf16_f32 v21, v21, v21
  v_cvt_pk_bf16_f32 v22, v22, v22
  v_cvt_pk_bf16_f32 v23, v23, v23
  v_cvt_pk_bf16_f32 v24, v24, v24
  v_cvt_pk_bf16_f32 v25, v25, v25
  v_cvt_pk_bf16_f32 v26, v26, v26
  v_cvt_pk_bf16_f32 v27, v27, v27
  v_cvt_pk_bf16_f32 v28, v28, v28
  v_cvt_pk_bf16_f32 v29, v29, v29
  v_cvt_pk_bf16_f32 v30, v30, v30
  v_cvt_pk_bf16_f32 v31, v31, v31
  v_cvt_pk_bf16_f32 v32, v32, v32
  v_cvt_pk_bf16_f32 v33, v33, v33
  s_waitcnt vmcnt(3)
  buffer_load_dwordx4 v[140:143], v66, s[12:15], s34 offen
  s_add_u32 s34, s34, 8192
  s_add_u32 s33, s33, 1
  s_cmp_eq_u32 s33, 9
  s_cselect_b32 s33, 0, s33
  v_lshl_add_u32 v64, v64, 1, v6
  v_lshrrev_b32 v67, 3, v2
  v_mov_b32 v3, 1
  v_cmp_eq_u32 vcc, s28, v67
  s_and_saveexec_b64 s[34:35], vcc
  ds_write_b64 v64, v[16:17] offset:6592
  ds_write_b64 v64, v[18:19] offset:6600
  ds_write_b64 v64, v[20:21] offset:6608
  ds_write_b64 v64, v[22:23] offset:6616
  ds_write_b64 v64, v[24:25] offset:6624
  ds_write_b64 v64, v[26:27] offset:6632
  ds_write_b64 v64, v[28:29] offset:6640
  ds_write_b64 v64, v[30:31] offset:6648
  ds_write_b64 v64, v[32:33] offset:6656
  s_mov_b64 exec, -1
  v_lshl_add_u32 v67, v65, 2, v6
  s_waitcnt lgkmcnt(0)
  v_and_b32 v68, 4, v4
  v_lshlrev_b32 v68, 2, v68
  v_mov_b32 v69, 0xffff
  v_lshlrev_b32 v68, v68, v69
  v_and_b32 v69, 3, v4
  v_lshrrev_b32 v32, 3, v4
  v_lshl_add_u32 v69, v69, 1, v32
  v_cmp_eq_u32 vcc, 0, v69
  s_nop 1
  v_cndmask_b32 v32, 0, v68, vcc
  v_cmp_eq_u32 vcc, 1, v69
  s_nop 1
  v_cndmask_b32 v33, 0, v68, vcc
  v_cmp_eq_u32 vcc, 2, v69
  s_nop 1
  v_cndmask_b32 v34, 0, v68, vcc
  v_cmp_eq_u32 vcc, 3, v69
  s_nop 1
  v_cndmask_b32 v35, 0, v68, vcc
  v_mov_b32 v44, 0
  v_mov_b32 v45, 0
  v_mov_b32 v46, 0
  v_mov_b32 v47, 0
  s_mov_b32 s77, 2
L_h_q:
  s_lshl_b32 s3, s32, 6
  v_add_u32 v68, s3, v67
  ds_read_b128 v[48:51], v68 offset:6592
  s_add_u32 s32, s32, 1
  s_cmp_eq_u32 s32, 9
  s_cselect_b32 s32, 0, s32
  s_lshl_b32 s34, s33, 17
  s_cmp_ge_u32 s77, 9
  s_cselect_b32 s14, 0, s14
  s_add_u32 s33, s33, 1
  s_cmp_eq_u32 s33, 9
  s_cselect_b32 s33, 0, s33
  s_add_u32 s77, s77, 1
  s_waitcnt lgkmcnt(0)
  v_and_b32 v36, v48, v32
  v_and_b32 v37, v48, v33
  v_and_b32 v38, v48, v34
  v_and_b32 v39, v48, v35
  s_waitcnt vmcnt(3)
  s_nop 0
  v_mfma_f32_16x16x32_bf16 v[44:47], v[36:39], v[112:115], v[44:47]
  buffer_load_dwordx4 v[112:115], v66, s[12:15], s34 offen
  s_add_u32 s34, s34, 8192
  v_and_b32 v40, v49, v32
  v_and_b32 v41, v49, v33
  v_and_b32 v42, v49, v34
  v_and_b32 v43, v49, v35
  s_waitcnt vmcnt(3)
  s_nop 0
  v_mfma_f32_16x16x32_bf16 v[44:47], v[40:43], v[116:119], v[44:47]
  buffer_load_dwordx4 v[116:119], v66, s[12:15], s34 offen
  s_add_u32 s34, s34, 8192
  v_and_b32 v36, v50, v32
  v_and_b32 v37, v50, v33
  v_and_b32 v38, v50, v34
  v_and_b32 v39, v50, v35
  s_waitcnt vmcnt(3)
  s_nop 0
  v_mfma_f32_16x16x32_bf16 v[44:47], v[36:39], v[120:123], v[44:47]
  buffer_load_dwordx4 v[120:123], v66, s[12:15], s34 offen
  s_add_u32 s34, s34, 8192
  v_and_b32 v40, v51, v32
  v_and_b32 v41, v51, v33
  v_and_b32 v42, v51, v34
  v_and_b32 v43, v51, v35
  s_waitcnt vmcnt(3)
  s_nop 0
  v_mfma_f32_16x16x32_bf16 v[44:47], v[40:43], v[124:127], v[44:47]
  buffer_load_dwordx4 v[124:127], v66, s[12:15], s34 offen
  s_add_u32 s34, s34, 8192
  s_cmp_eq_u32 s77, 11
  s_cbranch_scc1 L_h_q_done
  s_lshl_b32 s3, s32, 6
  v_add_u32 v68, s3, v67
  ds_read_b128 v[48:51], v68 offset:6592
  s_add_u32 s32, s32, 1
  s_cmp_eq_u32 s32, 9
  s_cselect_b32 s32, 0, s32
  s_lshl_b32 s34, s33, 17
  s_cmp_ge_u32 s77, 9
  s_cselect_b32 s14, 0, s14
  s_add_u32 s33, s33, 1
  s_cmp_eq_u32 s33, 9
  s_cselect_b32 s33, 0, s33
  s_add_u32 s77, s77, 1
  s_waitcnt lgkmcnt(0)
  v_and_b32 v36, v48, v32
  v_and_b32 v37, v48, v33
  v_and_b32 v38, v48, v34
  v_and_b32 v39, v48, v35
  s_waitcnt vmcnt(3)
  s_nop 0
  v_mfma_f32_16x16x32_bf16 v[44:47], v[36:39], v[128:131], v[44:47]
  buffer_load_dwordx4 v[128:131], v66, s[12:15], s34 offen
  s_add_u32 s34, s34, 8192
  v_and_b32 v40, v49, v32
  v_and_b32 v41, v49, v33
  v_and_b32 v42, v49, v34
  v_and_b32 v43, v49, v35
  s_waitcnt vmcnt(3)
  s_nop 0
  v_mfma_f32_16x16x32_bf16 v[44:47], v[40:43], v[132:135], v[44:47]
  buffer_load_dwordx4 v[132:135], v66, s[12:15], s34 offen
  s_add_u32 s34, s34, 8192
  v_and_b32 v36, v50, v32
  v_and_b32 v37, v50, v33
  v_and_b32 v38, v50, v34
  v_and_b32 v39, v50, v35
  s_waitcnt vmcnt(3)
  s_nop 0
  v_mfma_f32_16x16x32_bf16 v[44:47], v[36:39], v[136:139], v[44:47]
  buffer_load_dwordx4 v[136:139], v66, s[12:15], s34 offen
  s_add_u32 s34, s34, 8192
  v_and_b32 v40, v51, v32
  v_and_b32 v41, v51, v33
  v_and_b32 v42, v51, v34
  v_and_b32 v43, v51, v35
  s_waitcnt vmcnt(3)
  s_nop 0
  v_mfma_f32_16x16x32_bf16 v[44:47], v[40:43], v[140:143], v[44:47]
  buffer_load_dwordx4 v[140:143], v66, s[12:15], s34 offen
  s_add_u32 s34, s34, 8192
  s_branch L_h_q
L_h_q_done:
  v_subrev_u32 v68, 256, v0
  v_lshl_add_u32 v68, v68, 3, v6
  s_nop 1
  ds_write_b64 v68, v[44:45] offset:4096
  s_waitcnt lgkmcnt(0)
  s_mov_b64 exec, 1
  ds_add_rtn_u32 v69, v6, v3 offset:6212
  s_mov_b64 exec, -1
  v_lshl_add_u32 v11, v2, 3, v6
  s_waitcnt lgkmcnt(0)
  v_readfirstlane_b32 s3, v69
  s_cmp_lg_u32 s3, 3
  s_cbranch_scc1 L_h_q_out
  ds_read_b64 v[48:49], v11 offset:4096
  ds_read_b64 v[50:51], v11 offset:4608
  ds_read_b64 v[52:53], v11 offset:5120
  ds_read_b64 v[54:55], v11 offset:5632
  v_lshl_add_u32 v69, v4, 3, v5
  v_lshl_add_u32 v69, v69, 1, v6
  s_waitcnt lgkmcnt(0)
  v_pk_add_f32 v[48:49], v[48:49], v[50:51]
  v_pk_add_f32 v[52:53], v[52:53], v[54:55]
  v_pk_add_f32 v[48:49], v[48:49], v[52:53]
  v_cvt_pk_bf16_f32 v48, v48, v49
  ds_write_b16 v69, v48 offset:6272
  ds_write_b16_d16_hi v69, v48 offset:6280
  s_waitcnt lgkmcnt(0)
  ds_write_b32 v6, v3 offset:6216
L_h_q_out:
  s_setprio 0
  s_and_b32 s3, s2, 40
  s_cmp_lg_u32 s3, 0
  s_cbranch_scc1 L_h_noreport
  s_bfe_u32 s3, s2, 196608
  s_bfe_u32 s35, s2, 65540
  s_lshl_b32 s35, s35, 3
  s_or_b32 s3, s3, s35
  s_bfe_u32 s35, s2, 131078
  s_lshl_b32 s35, s35, 4
  s_or_b32 s3, s3, s35
  s_lshl_b32 s3, s3, 2
  v_mov_b32 v70, s3
  s_waitcnt vmcnt(0)
  s_mov_b64 exec, 1
  ds_add_rtn_u32 v69, v6, v3 offset:6208
  s_waitcnt lgkmcnt(0)
  v_readfirstlane_b32 s3, v69
  s_cmp_lg_u32 s3, 3
  s_cbranch_scc1 L_h_noflag
  global_store_dword v70, v3, s[58:59] sc1
L_h_noflag:
  s_mov_b64 exec, -1
L_h_noreport:
  s_and_b32 s31, s2, 7
  s_lshl_b32 s31, s31, 2
  s_bfe_u32 s3, s2, 0x20003
  s_add_u32 s31, s31, s3
  s_mul_i32 s3, s31, 288
  s_add_u32 s12, s48, s3
  s_addc_u32 s13, s49, 0
  s_mov_b32 s14, 5299488
  s_mov_b32 s15, 0x20000
  s_add_u32 s20, s50, s3
  s_addc_u32 s21, s51, 0
  s_mov_b32 s22, 288
  s_mov_b32 s23, 0x20000
  v_mul_u32_u24 v66, 9216, v65
  v_lshl_add_u32 v69, v4, 1, v66
  v_lshl_add_u32 v66, v4, 4, v66
  v_and_b32 v70, 8, v2
  v_bfe_u32 v71, v2, 5, 1
  v_lshl_add_u32 v70, v71, 2, v70
  v_and_b32 v71, 1, v2
  v_lshl_add_u32 v70, v71, 1, v70
  v_bfe_u32 v71, v2, 2, 1
  v_add_u32 v70, v70, v71
  v_bfe_u32 v71, v2, 4, 1
  v_bfe_u32 v72, v2, 1, 1
  v_lshl_add_u32 v71, v71, 1, v72
  v_lshl_add_u32 v11, v71, 4, v70
  v_lshl_add_u32 v11, v11, 3, v6
  v_lshl_add_u32 v70, v70, 3, v71
  v_lshlrev_b32 v70, 1, v70
  v_lshlrev_b32 v71, 1, v4
  s_waitcnt vmcnt(0)
  buffer_load_ushort v60, v70, s[20:23], 0 offen
  buffer_load_ushort v61, v70, s[20:23], 0 offen offset:8
  buffer_load_ushort v62, v71, s[20:23], 0 offen offset:256
  v_mov_b32 v44, 0
  v_mov_b32 v52, 0
  v_mov_b32 v45, 0
  v_mov_b32 v53, 0
  v_mov_b32 v46, 0
  v_mov_b32 v54, 0
  v_mov_b32 v47, 0
  v_mov_b32 v55, 0
  s_mov_b32 s32, s30
  s_mov_b32 s77, 9
L_h_h:
  s_lshl_b32 s3, s32, 6
  v_add_u32 v68, s3, v67
  ds_read_b128 v[48:51], v68 offset:6592
  s_mul_i32 s34, s32, 147456
  s_add_u32 s32, s32, 1
  s_cmp_eq_u32 s32, 9
  s_cselect_b32 s32, 0, s32
  buffer_load_dwordx4 v[112:115], v66, s[12:15], s34 offen
  buffer_load_ushort v128, v69, s[12:15], s34 offen offset:256
  s_add_u32 s34, s34, 9216
  buffer_load_dwordx4 v[116:119], v66, s[12:15], s34 offen
  buffer_load_ushort v129, v69, s[12:15], s34 offen offset:256
  s_add_u32 s34, s34, 9216
  s_waitcnt lgkmcnt(0)
  v_and_b32 v36, v48, v32
  v_and_b32 v37, v48, v33
  v_and_b32 v38, v48, v34
  v_and_b32 v39, v48, v35
  v_and_b32 v40, v49, v32
  v_and_b32 v41, v49, v33
  v_and_b32 v42, v49, v34
  v_and_b32 v43, v49, v35
  v_perm_b32 v56, v49, v48, s94
  s_waitcnt vmcnt(0)
  v_lshl_or_b32 v58, v129, 16, v128
  v_mfma_f32_16x16x32_bf16 v[44:47], v[36:39], v[112:115], v[44:47]
  v_mfma_f32_16x16x32_bf16 v[44:47], v[40:43], v[116:119], v[44:47]
  buffer_load_dwordx4 v[120:123], v66, s[12:15], s34 offen
  buffer_load_ushort v130, v69, s[12:15], s34 offen offset:256
  s_add_u32 s34, s34, 9216
  buffer_load_dwordx4 v[124:127], v66, s[12:15], s34 offen
  buffer_load_ushort v131, v69, s[12:15], s34 offen offset:256
  s_add_u32 s34, s34, 9216
  s_waitcnt lgkmcnt(0)
  v_and_b32 v36, v50, v32
  v_and_b32 v37, v50, v33
  v_and_b32 v38, v50, v34
  v_and_b32 v39, v50, v35
  v_and_b32 v40, v51, v32
  v_and_b32 v41, v51, v33
  v_and_b32 v42, v51, v34
  v_and_b32 v43, v51, v35
  v_perm_b32 v57, v51, v50, s94
  s_waitcnt vmcnt(0)
  v_lshl_or_b32 v59, v131, 16, v130
  v_mfma_f32_16x16x32_bf16 v[44:47], v[36:39], v[120:123], v[44:47]
  v_mfma_f32_16x16x32_bf16 v[44:47], v[40:43], v[124:127], v[44:47]
  v_mfma_f32_16x16x16_bf16 v[52:55], v[56:57], v[58:59], v[52:55]
  s_sub_u32 s77, s77, 1
  s_cmp_lg_u32 s77, 0
  s_cbranch_scc1 L_h_h
  v_lshl_add_u32 v68, v0, 3, v6
  s_lshl_b32 s3, s28, 6
  v_lshl_add_u32 v70, v4, 2, v6
  v_add_u32 v70, s3, v70
  s_nop 1
  ds_write_b64 v68, v[44:45] offset:0
  ds_write_b32 v70, v52 offset:9984
  s_waitcnt lgkmcnt(0)
  s_mov_b64 exec, 1
  ds_add_u32 v6, v3 offset:6220
  s_mov_b64 exec, -1
  v_mul_u32_u24 v7, 1152, v5
  v_lshl_add_u32 v8, v4, 1, v7
  s_lshl_b32 s3, s28, 5
  s_add_u32 s3, s3, 1024
  v_add_u32 v8, s3, v8
  s_lshl_b32 s3, s28, 8
  v_lshl_add_u32 v7, v4, 4, v7
  v_add_u32 v7, s3, v7
  v_lshlrev_b32 v9, 5, v4
  v_lshl_add_u32 v9, v5, 4, v9
  s_lshl_b32 s3, s28, 9
  v_add_u32 v9, s3, v9
  v_mov_b32 v64, 0x10000000
  v_cmp_gt_u32 vcc, 2, v5
  s_lshl_b32 s3, s28, 6
  s_add_u32 s3, s3, 2048
  v_cndmask_b32 v9, v64, v9, vcc
  v_lshl_add_u32 v10, v4, 2, s3
  v_cmp_eq_u32 vcc, 0, v5
  s_nop 1
  v_cndmask_b32 v10, v64, v10, vcc
  s_mov_b32 s96, 0xf0f0f0f0
  s_mov_b32 s97, s96
  s_mul_i32 s3, s31, 165888
  s_add_u32 s20, s52, s3
  s_addc_u32 s21, s53, 0
  s_mov_b32 s22, 165888
  s_mov_b32 s23, 0x20000
  s_mov_b32 s33, 147456
  buffer_load_dwordx4 v[28:31], v7, s[20:23], s33 offen
  buffer_load_ushort v44, v8, s[20:23], s33 offen
  s_mov_b32 s33, 152064
  buffer_load_dwordx4 v[32:35], v7, s[20:23], s33 offen
  buffer_load_ushort v45, v8, s[20:23], s33 offen
  s_mov_b32 s33, 156672
  buffer_load_dwordx4 v[36:39], v7, s[20:23], s33 offen
  buffer_load_ushort v46, v8, s[20:23], s33 offen
  s_mov_b32 s33, 161280
  buffer_load_dwordx4 v[40:43], v7, s[20:23], s33 offen
  buffer_load_ushort v47, v8, s[20:23], s33 offen
  s_waitcnt vmcnt(0)
  v_perm_b32 v64, v32, v28, s94
  v_perm_b32 v66, v32, v28, s95
  v_perm_b32 v68, v33, v29, s94
  v_perm_b32 v70, v33, v29, s95
  v_perm_b32 v72, v34, v30, s94
  v_perm_b32 v74, v34, v30, s95
  v_perm_b32 v76, v35, v31, s94
  v_perm_b32 v78, v35, v31, s95
  v_lshl_or_b32 v80, v45, 16, v44
  v_perm_b32 v65, v40, v36, s94
  v_perm_b32 v67, v40, v36, s95
  v_perm_b32 v69, v41, v37, s94
  v_perm_b32 v71, v41, v37, s95
  v_perm_b32 v73, v42, v38, s94
  v_perm_b32 v75, v42, v38, s95
  v_perm_b32 v77, v43, v39, s94
  v_perm_b32 v79, v43, v39, s95
  v_lshl_or_b32 v81, v47, 16, v46
  s_call_b64 s[62:63], L_sub_load
L_h_hwait:
  ds_read_b32 v104, v6 offset:6220
  s_waitcnt lgkmcnt(0)
  v_readfirstlane_b32 s3, v104
  s_cmp_ge_u32 s3, 4
  s_cbranch_scc1 L_h_hwait_ok
  s_sleep 1
  s_sub_u32 s69, s69, 1
  s_cbranch_scc0 L_h_hwait
  s_mov_b32 s69, 0
L_h_hwait_ok:
  v_lshl_add_u32 v104, v4, 2, v6
  ds_read_b64 v[16:17], v11 offset:2048
  ds_read_b32 v18, v104 offset:9984
  ds_read_b64 v[20:21], v11 offset:2560
  ds_read_b32 v22, v104 offset:10048
  ds_read_b64 v[24:25], v11 offset:3072
  ds_read_b32 v26, v104 offset:10112
  ds_read_b64 v[28:29], v11 offset:3584
  ds_read_b32 v30, v104 offset:10176
  v_and_b32 v104, 3, v4
  v_lshrrev_b32 v105, 2, v4
  v_lshl_add_u32 v104, v104, 2, v105
  v_lshl_add_u32 v104, v104, 1, v6
  s_waitcnt lgkmcnt(0)
  v_add_f32 v16, v16, v20
  v_add_f32 v24, v24, v28
  v_add_f32 v16, v16, v24
  v_cvt_pk_bf16_f32 v16, v16, v16
  v_and_b32 v16, 0xffff0000, v16
  v_lshlrev_b32 v60, 16, v60
  v_add_f32 v16, v16, v60
  v_cvt_pk_bf16_f32 v16, v16, v16
  v_and_b32 v16, 0xffff0000, v16
  v_mul_f32 v60, v16, v16
  v_mov_b32 v19, 0xc0135761
  v_fmac_f32 v19, 0xbdd2d3e8, v60
  v_mul_f32 v60, v19, v16
  v_exp_f32 v60, v60
  s_nop 0
  v_add_f32 v60, 1.0, v60
  v_rcp_f32 v60, v60
  s_nop 0
  v_mul_f32 v16, v16, v60
  v_cvt_pk_bf16_f32 v110, v16, v16
  v_and_b32 v110, 0xffff0000, v110
  v_add_f32 v17, v17, v21
  v_add_f32 v25, v25, v29
  v_add_f32 v17, v17, v25
  v_cvt_pk_bf16_f32 v17, v17, v17
  v_and_b32 v17, 0xffff0000, v17
  v_lshlrev_b32 v61, 16, v61
  v_add_f32 v17, v17, v61
  v_cvt_pk_bf16_f32 v17, v17, v17
  v_and_b32 v17, 0xffff0000, v17
  v_mul_f32 v61, v17, v17
  v_mov_b32 v19, 0xc0135761
  v_fmac_f32 v19, 0xbdd2d3e8, v61
  v_mul_f32 v61, v19, v17
  v_exp_f32 v61, v61
  s_nop 0
  v_add_f32 v61, 1.0, v61
  v_rcp_f32 v61, v61
  s_nop 0
  v_mul_f32 v17, v17, v61
  v_cvt_pk_bf16_f32 v111, v17, v17
  v_and_b32 v111, 0xffff0000, v111
  v_add_f32 v18, v18, v22
  v_add_f32 v26, v26, v30
  v_add_f32 v18, v18, v26
  v_cvt_pk_bf16_f32 v18, v18, v18
  v_and_b32 v18, 0xffff0000, v18
  v_lshlrev_b32 v62, 16, v62
  v_add_f32 v18, v18, v62
  v_cvt_pk_bf16_f32 v18, v18, v18
  v_and_b32 v18, 0xffff0000, v18
  v_mul_f32 v62, v18, v18
  v_mov_b32 v19, 0xc0135761
  v_fmac_f32 v19, 0xbdd2d3e8, v62
  v_mul_f32 v62, v19, v18
  v_exp_f32 v62, v62
  s_nop 0
  v_add_f32 v62, 1.0, v62
  v_rcp_f32 v62, v62
  s_nop 0
  v_mul_f32 v18, v18, v62
  v_cvt_pk_bf16_f32 v18, v18, v18
  v_and_b32 v18, 0xffff0000, v18
  ds_write_b16_d16_hi v104, v18 offset:6528
  s_waitcnt lgkmcnt(0)
  v_lshl_add_u32 v104, v5, 3, v6
  ds_read_b64 v[106:107], v104 offset:6528
  s_lshl_b32 s3, s29, 3
  s_add_u32 s3, s3, s30
  s_mul_i32 s3, s3, 4608
  s_add_u32 s24, s60, s3
  s_addc_u32 s25, s61, 0
  s_mov_b32 s26, 0
  s_mov_b32 s27, 0x20000
  s_waitcnt lgkmcnt(0)
  v_cndmask_b32 v106, v106, 0, s[96:97]
  v_cndmask_b32 v107, v107, 0, s[96:97]
  v_mov_b32 v96, 0x4444
  v_mov_b32 v97, 0xeeee
  v_cndmask_b32 v96, v96, v97, s[96:97]
  v_mfma_f32_16x16x16_bf16 v[16:19], v[106:107], v[64:65], 0
  v_mfma_f32_16x16x16_bf16 v[20:23], v[106:107], v[66:67], 0
  v_mfma_f32_16x16x16_bf16 v[24:27], v[106:107], v[68:69], 0
  v_mfma_f32_16x16x16_bf16 v[28:31], v[106:107], v[70:71], 0
  v_mfma_f32_16x16x16_bf16 v[32:35], v[106:107], v[72:73], 0
  v_mfma_f32_16x16x16_bf16 v[36:39], v[106:107], v[74:75], 0
  v_mfma_f32_16x16x16_bf16 v[40:43], v[106:107], v[76:77], 0
  v_mfma_f32_16x16x16_bf16 v[44:47], v[106:107], v[78:79], 0
  v_mfma_f32_16x16x16_bf16 v[48:51], v[106:107], v[80:81], 0
  v_add_u32 v11, 10240, v11
  s_call_b64 s[62:63], L_sub_gemv
  v_subrev_u32 v11, 10240, v11
  v_mov_b32 v20, v68
  v_mov_b32 v21, v69
  v_mov_b32 v22, v70
  v_mov_b32 v23, v71
  v_mov_b32 v24, v48
  s_mov_b32 s26, 4608
  s_mov_b64 exec, 1
  ds_add_u32 v6, v3 offset:6232
  s_mov_b64 exec, -1
  s_mul_i32 s3, s29, 147456
  s_add_u32 s20, s44, s3
  s_addc_u32 s21, s45, 0
  s_mov_b32 s22, 147456
  s_mov_b32 s23, 0x20000
  s_call_b64 s[62:63], L_sub_load
  s_cmp_lg_u32 s28, 3
  s_cbranch_scc1 L_h_pvpre
  v_and_b32 v105, 63, v2
  v_lshlrev_b32 v105, 2, v105
  global_load_dword v104, v105, s[58:59]
L_h_bpoll:
  s_waitcnt vmcnt(0)
  v_cmp_ne_u32 vcc, 1, v104
  s_cbranch_vccz L_h_bpoll_ok
  s_sleep 32
  global_load_dword v104, v105, s[58:59] sc1
  s_sub_u32 s69, s69, 16
  s_cbranch_scc0 L_h_bpoll
  s_mov_b32 s69, 0
  s_waitcnt vmcnt(0)
L_h_bpoll_ok:
  s_and_b32 s33, s29, 15
  s_cmp_ge_u32 s33, 9
  s_cbranch_scc1 L_h_pvpre
  s_lshl_b32 s33, s33, 6
  s_and_b32 s3, s29, 16
  s_lshl_b32 s3, s3, 1
  s_add_u32 s33, s33, s3
  s_lshr_b32 s68, s2, 5
  s_mul_i32 s3, s68, 4608
  s_add_u32 s12, s60, s3
  s_addc_u32 s13, s61, 0
  s_mov_b32 s14, 0
  s_mov_b32 s15, 0x20000
  s_mov_b32 s16, s56
  s_mov_b32 s17, s57
  s_mov_b32 s18, 0
  s_mov_b32 s19, 0x20000
  s_mov_b32 s65, 294912
  s_mov_b32 s66, 589824
  s_mov_b32 s67, 884736
  s_mul_i32 s68, s68, 1152
  v_lshrrev_b32 v104, 3, v2
  v_mul_u32_u24 v104, 36864, v104
  v_and_b32 v105, 7, v2
  v_lshl_add_u32 v105, v105, 2, s33
  v_lshl_add_u32 v15, v105, 2, v104
  v_bfe_u32 v106, v2, 4, 1
  v_lshrrev_b32 v107, 5, v2
  v_lshl_add_u32 v106, v106, 1, v107
  v_add_lshl_u32 v14, v106, v105, 1
  s_mov_b32 s20, s54
  s_mov_b32 s21, s55
  s_mov_b32 s22, 1152
  s_mov_b32 s23, 0x20000
  buffer_load_ushort v13, v14, s[8:11], s68 offen
  buffer_load_ushort v12, v14, s[20:23], 0 offen
  s_waitcnt vmcnt(0)
  v_lshlrev_b32 v13, 16, v13
  v_lshlrev_b32 v12, 16, v12
  v_mov_b32 v104, 0x10000000
  v_and_b32 v105, 8, v2
  v_cmp_eq_u32 vcc, 0, v105
  s_nop 1
  v_cndmask_b32 v14, v104, v14, vcc
  v_lshl_add_u32 v104, v2, 4, v6
  ds_write_b128 v104, v[12:15] offset:8960
  s_call_b64 s[62:63], L_sub_final
  s_waitcnt vmcnt(0)
L_h_pvpre:
  v_and_b32 v28, 4, v4
  v_lshlrev_b32 v28, 2, v28
  v_mov_b32 v29, 0xffff
  v_lshlrev_b32 v28, v28, v29
  v_and_b32 v29, 3, v4
  v_lshrrev_b32 v32, 3, v4
  v_lshl_add_u32 v29, v29, 1, v32
  v_cmp_eq_u32 vcc, 0, v29
  s_nop 1
  v_cndmask_b32 v32, 0, v28, vcc
  v_cmp_eq_u32 vcc, 1, v29
  s_nop 1
  v_cndmask_b32 v33, 0, v28, vcc
  v_cmp_eq_u32 vcc, 2, v29
  s_nop 1
  v_cndmask_b32 v34, 0, v28, vcc
  v_cmp_eq_u32 vcc, 3, v29
  s_nop 1
  v_cndmask_b32 v35, 0, v28, vcc
  v_mov_b32 v44, 0
  v_mov_b32 v45, 0
  v_mov_b32 v46, 0
  v_mov_b32 v47, 0
L_h_s2wait:
  ds_read_b32 v28, v6 offset:6232
  s_waitcnt lgkmcnt(0)
  v_readfirstlane_b32 s3, v28
  s_cmp_ge_u32 s3, 4
  s_cbranch_scc1 L_h_s2wait_ok
  s_sleep 4
  s_sub_u32 s69, s69, 1
  s_cbranch_scc0 L_h_s2wait
  s_mov_b32 s69, 0
L_h_s2wait_ok:
L_h_smwait:
  ds_read_b32 v28, v6 offset:6224
  s_waitcnt lgkmcnt(0)
  v_readfirstlane_b32 s3, v28
  s_cmp_ge_u32 s3, 4
  s_cbranch_scc1 L_h_smwait_ok
  s_sleep 4
  s_sub_u32 s69, s69, 1
  s_cbranch_scc0 L_h_smwait
  s_mov_b32 s69, 0
L_h_smwait_ok:
  s_lshl_b32 s3, s28, 3
  v_add_u32 v28, s3, v6
  ds_read_b32 v29, v28 offset:6144
  s_lshl_b32 s3, s28, 9
  v_lshl_add_u32 v28, v2, 2, v6
  v_add_u32 v28, s3, v28
  ds_read_b32 v18, v28 offset:4096
  ds_read_b32 v19, v28 offset:4352
  ds_read_b128 v[48:51], v6 offset:6144
  ds_read_b128 v[52:55], v6 offset:6160
  s_waitcnt lgkmcnt(0)
  v_max3_f32 v56, v48, v50, v52
  v_max_f32 v56, v56, v54
  v_sub_f32 v48, v48, v56
  v_sub_f32 v50, v50, v56
  v_sub_f32 v52, v52, v56
  v_sub_f32 v54, v54, v56
  v_sub_f32 v57, v29, v56
  v_mul_f32 v48, 0x3fb8aa3b, v48
  v_mul_f32 v50, 0x3fb8aa3b, v50
  v_mul_f32 v52, 0x3fb8aa3b, v52
  v_mul_f32 v54, 0x3fb8aa3b, v54
  v_mul_f32 v57, 0x3fb8aa3b, v57
  v_exp_f32 v48, v48
  v_exp_f32 v50, v50
  v_exp_f32 v52, v52
  v_exp_f32 v54, v54
  v_exp_f32 v57, v57
  v_mul_f32 v56, v48, v49
  v_fmac_f32 v56, v50, v51
  v_fmac_f32 v56, v52, v53
  v_fmac_f32 v56, v54, v55
  v_rcp_f32 v56, v56
  s_nop 0
  v_mul_f32 v28, v57, v56
  v_mul_f32 v18, v18, v28
  v_cvt_pk_bf16_f32 v18, v18, v18
  v_mul_f32 v19, v19, v28
  v_cvt_pk_bf16_f32 v19, v19, v19
  s_lshl_b32 s3, s28, 15
  v_lshl_add_u32 v28, v2, 4, s3
  s_mov_b32 s34, 2
L_h_pv:
  ds_read_b128 v[48:51], v28 offset:0
  ds_read_b128 v[52:55], v28 offset:1024
  ds_read_b128 v[56:59], v28 offset:2048
  ds_read_b128 v[60:63], v28 offset:3072
  ds_read_b128 v[64:67], v28 offset:4096
  ds_read_b128 v[68:71], v28 offset:5120
  ds_read_b128 v[72:75], v28 offset:6144
  ds_read_b128 v[76:79], v28 offset:7168
  s_waitcnt lgkmcnt(0)
  ds_read_b128 v[80:83], v28 offset:8192
  ds_read_b128 v[84:87], v28 offset:9216
  ds_read_b128 v[88:91], v28 offset:10240
  ds_read_b128 v[92:95], v28 offset:11264
  ds_read_b128 v[96:99], v28 offset:12288
  ds_read_b128 v[100:103], v28 offset:13312
  ds_read_b128 v[104:107], v28 offset:14336
  ds_read_b128 v[108:111], v28 offset:15360
  s_waitcnt lgkmcnt(0)
  s_call_b64 s[62:63], L_sub_pv
  v_mov_b32 v18, v19
  v_add_u32 v28, 16384, v28
  s_sub_u32 s34, s34, 1
  s_cmp_lg_u32 s34, 0
  s_cbranch_scc1 L_h_pv
  v_lshl_add_u32 v28, v0, 3, v6
  s_nop 1
  ds_write_b64 v28, v[44:45] offset:0
  v_mov_b32 v82, v20
  v_mov_b32 v83, v21
  v_mov_b32 v84, v22
  v_mov_b32 v85, v23
  v_mov_b32 v86, v24
  s_waitcnt lgkmcnt(0)
  s_mov_b64 exec, 1
  ds_add_u32 v6, v3 offset:6228
  s_mov_b64 exec, -1
  v_mov_b32 v16, 0
  v_mov_b32 v17, 0
  v_mov_b32 v18, 0
  v_mov_b32 v19, 0
  v_mov_b32 v20, 0
  v_mov_b32 v21, 0
  v_mov_b32 v22, 0
  v_mov_b32 v23, 0
  v_mov_b32 v24, 0
  v_mov_b32 v25, 0
  v_mov_b32 v26, 0
  v_mov_b32 v27, 0
  v_mov_b32 v28, 0
  v_mov_b32 v29, 0
  v_mov_b32 v30, 0
  v_mov_b32 v31, 0
  v_mov_b32 v32, 0
  v_mov_b32 v33, 0
  v_mov_b32 v34, 0
  v_mov_b32 v35, 0
  v_mov_b32 v36, 0
  v_mov_b32 v37, 0
  v_mov_b32 v38, 0
  v_mov_b32 v39, 0
  v_mov_b32 v40, 0
  v_mov_b32 v41, 0
  v_mov_b32 v42, 0
  v_mov_b32 v43, 0
  v_mov_b32 v44, 0
  v_mov_b32 v45, 0
  v_mov_b32 v46, 0
  v_mov_b32 v47, 0
  v_mov_b32 v48, 0
  v_mov_b32 v49, 0
  v_mov_b32 v50, 0
  v_mov_b32 v51, 0
L_h_pvwait:
  ds_read_b32 v104, v6 offset:6228
  s_waitcnt lgkmcnt(0)
  v_readfirstlane_b32 s3, v104
  s_cmp_ge_u32 s3, 4
  s_cbranch_scc1 L_h_pvwait_ok
  s_sleep 1
  s_sub_u32 s69, s69, 1
  s_cbranch_scc0 L_h_pvwait
  s_mov_b32 s69, 0
L_h_pvwait_ok:
  ds_read_b64 v[64:65], v11 offset:2048
  ds_read_b64 v[66:67], v11 offset:2560
  ds_read_b64 v[68:69], v11 offset:3072
  ds_read_b64 v[70:71], v11 offset:3584
  s_waitcnt lgkmcnt(0)
  v_add_f32 v64, v64, v66
  v_add_f32 v68, v68, v70
  v_add_f32 v110, v64, v68
  v_add_f32 v65, v65, v67
  v_add_f32 v69, v69, v71
  v_add_f32 v111, v65, v69
  v_mov_b32 v96, 0x4444
  v_mov_b32 v97, 0xeeee
  v_cndmask_b32 v96, v96, v97, s[96:97]
  s_setprio 2
  s_barrier
  s_call_b64 s[62:63], L_sub_gemv
  s_waitcnt vmcnt(0)
  s_barrier
L_end:
  s_endpgm
L_sub_load:
  ds_read_b32 v104, v6 offset:6224
  s_waitcnt lgkmcnt(0)
  v_readfirstlane_b32 s3, v104
  s_cmp_lg_u32 s3, 0
  s_mov_b32 s33, 0
  s_mov_b32 s34, 4608
  buffer_load_dwordx4 v[28:31], v7, s[20:23], s33 offen
  buffer_load_dwordx4 v[32:35], v7, s[20:23], s34 offen
  buffer_load_ushort v36, v8, s[20:23], s33 offen
  buffer_load_ushort v37, v8, s[20:23], s34 offen
  s_cbranch_scc1 L_sl0
  s_waitcnt vmcnt(0)
L_sl0:
  s_mov_b32 s33, 9216
  s_mov_b32 s34, 13824
  buffer_load_dwordx4 v[38:41], v7, s[20:23], s33 offen
  buffer_load_dwordx4 v[42:45], v7, s[20:23], s34 offen
  buffer_load_ushort v46, v8, s[20:23], s33 offen
  buffer_load_ushort v47, v8, s[20:23], s34 offen
  s_waitcnt vmcnt(4)
  v_perm_b32 v112, v32, v28, s94
  v_perm_b32 v120, v32, v28, s95
  v_perm_b32 v128, v33, v29, s94
  v_perm_b32 v136, v33, v29, s95
  v_perm_b32 v144, v34, v30, s94
  v_perm_b32 v152, v34, v30, s95
  v_perm_b32 v160, v35, v31, s94
  v_perm_b32 v168, v35, v31, s95
  v_lshl_or_b32 v176, v37, 16, v36
  s_cbranch_scc1 L_sl1
  s_waitcnt vmcnt(0)
L_sl1:
  s_mov_b32 s33, 18432
  s_mov_b32 s34, 23040
  buffer_load_dwordx4 v[28:31], v7, s[20:23], s33 offen
  buffer_load_dwordx4 v[32:35], v7, s[20:23], s34 offen
  buffer_load_ushort v36, v8, s[20:23], s33 offen
  buffer_load_ushort v37, v8, s[20:23], s34 offen
  s_waitcnt vmcnt(4)
  v_perm_b32 v113, v42, v38, s94
  v_perm_b32 v121, v42, v38, s95
  v_perm_b32 v129, v43, v39, s94
  v_perm_b32 v137, v43, v39, s95
  v_perm_b32 v145, v44, v40, s94
  v_perm_b32 v153, v44, v40, s95
  v_perm_b32 v161, v45, v41, s94
  v_perm_b32 v169, v45, v41, s95
  v_lshl_or_b32 v177, v47, 16, v46
  s_cbranch_scc1 L_sl2
  s_waitcnt vmcnt(0)
L_sl2:
  s_mov_b32 s33, 27648
  s_mov_b32 s34, 32256
  buffer_load_dwordx4 v[38:41], v7, s[20:23], s33 offen
  buffer_load_dwordx4 v[42:45], v7, s[20:23], s34 offen
  buffer_load_ushort v46, v8, s[20:23], s33 offen
  buffer_load_ushort v47, v8, s[20:23], s34 offen
  s_waitcnt vmcnt(4)
  v_perm_b32 v114, v32, v28, s94
  v_perm_b32 v122, v32, v28, s95
  v_perm_b32 v130, v33, v29, s94
  v_perm_b32 v138, v33, v29, s95
  v_perm_b32 v146, v34, v30, s94
  v_perm_b32 v154, v34, v30, s95
  v_perm_b32 v162, v35, v31, s94
  v_perm_b32 v170, v35, v31, s95
  v_lshl_or_b32 v178, v37, 16, v36
  s_cbranch_scc1 L_sl3
  s_waitcnt vmcnt(0)
L_sl3:
  s_mov_b32 s33, 36864
  s_mov_b32 s34, 41472
  buffer_load_dwordx4 v[28:31], v7, s[20:23], s33 offen
  buffer_load_dwordx4 v[32:35], v7, s[20:23], s34 offen
  buffer_load_ushort v36, v8, s[20:23], s33 offen
  buffer_load_ushort v37, v8, s[20:23], s34 offen
  s_waitcnt vmcnt(4)
  v_perm_b32 v115, v42, v38, s94
  v_perm_b32 v123, v42, v38, s95
  v_perm_b32 v131, v43, v39, s94
  v_perm_b32 v139, v43, v39, s95
  v_perm_b32 v147, v44, v40, s94
  v_perm_b32 v155, v44, v40, s95
  v_perm_b32 v163, v45, v41, s94
  v_perm_b32 v171, v45, v41, s95
  v_lshl_or_b32 v179, v47, 16, v46
  s_cbranch_scc1 L_sl4
  s_waitcnt vmcnt(0)
L_sl4:
  s_mov_b32 s33, 46080
  s_mov_b32 s34, 50688
  buffer_load_dwordx4 v[38:41], v7, s[20:23], s33 offen
  buffer_load_dwordx4 v[42:45], v7, s[20:23], s34 offen
  buffer_load_ushort v46, v8, s[20:23], s33 offen
  buffer_load_ushort v47, v8, s[20:23], s34 offen
  s_waitcnt vmcnt(4)
  v_perm_b32 v116, v32, v28, s94
  v_perm_b32 v124, v32, v28, s95
  v_perm_b32 v132, v33, v29, s94
  v_perm_b32 v140, v33, v29, s95
  v_perm_b32 v148, v34, v30, s94
  v_perm_b32 v156, v34, v30, s95
  v_perm_b32 v164, v35, v31, s94
  v_perm_b32 v172, v35, v31, s95
  v_lshl_or_b32 v180, v37, 16, v36
  s_cbranch_scc1 L_sl5
  s_waitcnt vmcnt(0)
L_sl5:
  s_mov_b32 s33, 55296
  s_mov_b32 s34, 59904
  buffer_load_dwordx4 v[28:31], v7, s[20:23], s33 offen
  buffer_load_dwordx4 v[32:35], v7, s[20:23], s34 offen
  buffer_load_ushort v36, v8, s[20:23], s33 offen
  buffer_load_ushort v37, v8, s[20:23], s34 offen
  s_waitcnt vmcnt(4)
  v_perm_b32 v117, v42, v38, s94
  v_perm_b32 v125, v42, v38, s95
  v_perm_b32 v133, v43, v39, s94
  v_perm_b32 v141, v43, v39, s95
  v_perm_b32 v149, v44, v40, s94
  v_perm_b32 v157, v44, v40, s95
  v_perm_b32 v165, v45, v41, s94
  v_perm_b32 v173, v45, v41, s95
  v_lshl_or_b32 v181, v47, 16, v46
  s_cbranch_scc1 L_sl6
  s_waitcnt vmcnt(0)
L_sl6:
  s_mov_b32 s33, 64512
  s_mov_b32 s34, 69120
  buffer_load_dwordx4 v[38:41], v7, s[20:23], s33 offen
  buffer_load_dwordx4 v[42:45], v7, s[20:23], s34 offen
  buffer_load_ushort v46, v8, s[20:23], s33 offen
  buffer_load_ushort v47, v8, s[20:23], s34 offen
  s_waitcnt vmcnt(4)
  v_perm_b32 v118, v32, v28, s94
  v_perm_b32 v126, v32, v28, s95
  v_perm_b32 v134, v33, v29, s94
  v_perm_b32 v142, v33, v29, s95
  v_perm_b32 v150, v34, v30, s94
  v_perm_b32 v158, v34, v30, s95
  v_perm_b32 v166, v35, v31, s94
  v_perm_b32 v174, v35, v31, s95
  v_lshl_or_b32 v182, v37, 16, v36
  s_cbranch_scc1 L_sl7
  s_waitcnt vmcnt(0)
L_sl7:
  s_mov_b32 s33, 73728
  s_mov_b32 s34, 78336
  buffer_load_dwordx4 v[28:31], v7, s[20:23], s33 offen
  buffer_load_dwordx4 v[32:35], v7, s[20:23], s34 offen
  buffer_load_ushort v36, v8, s[20:23], s33 offen
  buffer_load_ushort v37, v8, s[20:23], s34 offen
  s_waitcnt vmcnt(4)
  v_perm_b32 v119, v42, v38, s94
  v_perm_b32 v127, v42, v38, s95
  v_perm_b32 v135, v43, v39, s94
  v_perm_b32 v143, v43, v39, s95
  v_perm_b32 v151, v44, v40, s94
  v_perm_b32 v159, v44, v40, s95
  v_perm_b32 v167, v45, v41, s94
  v_perm_b32 v175, v45, v41, s95
  v_lshl_or_b32 v183, v47, 16, v46
  s_cbranch_scc1 L_sl8
  s_waitcnt vmcnt(0)
L_sl8:
  s_mov_b32 s33, 82944
  s_mov_b32 s34, 87552
  buffer_load_dwordx4 v[38:41], v7, s[20:23], s33 offen
  buffer_load_dwordx4 v[42:45], v7, s[20:23], s34 offen
  buffer_load_ushort v46, v8, s[20:23], s33 offen
  buffer_load_ushort v47, v8, s[20:23], s34 offen
  s_waitcnt vmcnt(4)
  v_perm_b32 v184, v32, v28, s94
  v_perm_b32 v192, v32, v28, s95
  v_perm_b32 v200, v33, v29, s94
  v_perm_b32 v208, v33, v29, s95
  v_perm_b32 v216, v34, v30, s94
  v_perm_b32 v224, v34, v30, s95
  v_perm_b32 v232, v35, v31, s94
  v_perm_b32 v240, v35, v31, s95
  v_lshl_or_b32 v248, v37, 16, v36
  s_cbranch_scc1 L_sl9
  s_waitcnt vmcnt(0)
L_sl9:
  s_mov_b32 s33, 92160
  s_mov_b32 s34, 96768
  buffer_load_dwordx4 v[28:31], v7, s[20:23], s33 offen
  buffer_load_dwordx4 v[32:35], v7, s[20:23], s34 offen
  buffer_load_ushort v36, v8, s[20:23], s33 offen
  buffer_load_ushort v37, v8, s[20:23], s34 offen
  s_waitcnt vmcnt(4)
  v_perm_b32 v185, v42, v38, s94
  v_perm_b32 v193, v42, v38, s95
  v_perm_b32 v201, v43, v39, s94
  v_perm_b32 v209, v43, v39, s95
  v_perm_b32 v217, v44, v40, s94
  v_perm_b32 v225, v44, v40, s95
  v_perm_b32 v233, v45, v41, s94
  v_perm_b32 v241, v45, v41, s95
  v_lshl_or_b32 v249, v47, 16, v46
  s_cbranch_scc1 L_sl10
  s_waitcnt vmcnt(0)
L_sl10:
  s_mov_b32 s33, 101376
  s_mov_b32 s34, 105984
  buffer_load_dwordx4 v[38:41], v7, s[20:23], s33 offen
  buffer_load_dwordx4 v[42:45], v7, s[20:23], s34 offen
  buffer_load_ushort v46, v8, s[20:23], s33 offen
  buffer_load_ushort v47, v8, s[20:23], s34 offen
  s_waitcnt vmcnt(4)
  v_perm_b32 v186, v32, v28, s94
  v_perm_b32 v194, v32, v28, s95
  v_perm_b32 v202, v33, v29, s94
  v_perm_b32 v210, v33, v29, s95
  v_perm_b32 v218, v34, v30, s94
  v_perm_b32 v226, v34, v30, s95
  v_perm_b32 v234, v35, v31, s94
  v_perm_b32 v242, v35, v31, s95
  v_lshl_or_b32 v250, v37, 16, v36
  s_cbranch_scc1 L_sl11
  s_waitcnt vmcnt(0)
L_sl11:
  s_mov_b32 s33, 110592
  s_mov_b32 s34, 115200
  buffer_load_dwordx4 v[28:31], v7, s[20:23], s33 offen
  buffer_load_dwordx4 v[32:35], v7, s[20:23], s34 offen
  buffer_load_ushort v36, v8, s[20:23], s33 offen
  buffer_load_ushort v37, v8, s[20:23], s34 offen
  s_waitcnt vmcnt(4)
  v_perm_b32 v187, v42, v38, s94
  v_perm_b32 v195, v42, v38, s95
  v_perm_b32 v203, v43, v39, s94
  v_perm_b32 v211, v43, v39, s95
  v_perm_b32 v219, v44, v40, s94
  v_perm_b32 v227, v44, v40, s95
  v_perm_b32 v235, v45, v41, s94
  v_perm_b32 v243, v45, v41, s95
  v_lshl_or_b32 v251, v47, 16, v46
  s_cbranch_scc1 L_sl12
  s_waitcnt vmcnt(0)
L_sl12:
  s_mov_b32 s33, 119808
  s_mov_b32 s34, 124416
  buffer_load_dwordx4 v[38:41], v7, s[20:23], s33 offen
  buffer_load_dwordx4 v[42:45], v7, s[20:23], s34 offen
  buffer_load_ushort v46, v8, s[20:23], s33 offen
  buffer_load_ushort v47, v8, s[20:23], s34 offen
  s_waitcnt vmcnt(4)
  v_perm_b32 v188, v32, v28, s94
  v_perm_b32 v196, v32, v28, s95
  v_perm_b32 v204, v33, v29, s94
  v_perm_b32 v212, v33, v29, s95
  v_perm_b32 v220, v34, v30, s94
  v_perm_b32 v228, v34, v30, s95
  v_perm_b32 v236, v35, v31, s94
  v_perm_b32 v244, v35, v31, s95
  v_lshl_or_b32 v252, v37, 16, v36
  s_cbranch_scc1 L_sl13
  s_waitcnt vmcnt(0)
L_sl13:
  s_mov_b32 s33, 129024
  s_mov_b32 s34, 133632
  buffer_load_dwordx4 v[28:31], v7, s[20:23], s33 offen
  buffer_load_dwordx4 v[32:35], v7, s[20:23], s34 offen
  buffer_load_ushort v36, v8, s[20:23], s33 offen
  buffer_load_ushort v37, v8, s[20:23], s34 offen
  s_waitcnt vmcnt(4)
  v_perm_b32 v189, v42, v38, s94
  v_perm_b32 v197, v42, v38, s95
  v_perm_b32 v205, v43, v39, s94
  v_perm_b32 v213, v43, v39, s95
  v_perm_b32 v221, v44, v40, s94
  v_perm_b32 v229, v44, v40, s95
  v_perm_b32 v237, v45, v41, s94
  v_perm_b32 v245, v45, v41, s95
  v_lshl_or_b32 v253, v47, 16, v46
  s_cbranch_scc1 L_sl14
  s_waitcnt vmcnt(0)
L_sl14:
  s_mov_b32 s33, 138240
  s_mov_b32 s34, 142848
  buffer_load_dwordx4 v[38:41], v7, s[20:23], s33 offen
  buffer_load_dwordx4 v[42:45], v7, s[20:23], s34 offen
  buffer_load_ushort v46, v8, s[20:23], s33 offen
  buffer_load_ushort v47, v8, s[20:23], s34 offen
  s_waitcnt vmcnt(4)
  v_perm_b32 v190, v32, v28, s94
  v_perm_b32 v198, v32, v28, s95
  v_perm_b32 v206, v33, v29, s94
  v_perm_b32 v214, v33, v29, s95
  v_perm_b32 v222, v34, v30, s94
  v_perm_b32 v230, v34, v30, s95
  v_perm_b32 v238, v35, v31, s94
  v_perm_b32 v246, v35, v31, s95
  v_lshl_or_b32 v254, v37, 16, v36
  s_waitcnt vmcnt(0)
  v_perm_b32 v191, v42, v38, s94
  v_perm_b32 v199, v42, v38, s95
  v_perm_b32 v207, v43, v39, s94
  v_perm_b32 v215, v43, v39, s95
  v_perm_b32 v223, v44, v40, s94
  v_perm_b32 v231, v44, v40, s95
  v_perm_b32 v239, v45, v41, s94
  v_perm_b32 v247, v45, v41, s95
  v_lshl_or_b32 v255, v47, 16, v46
  s_setpc_b64 s[62:63]
L_sub_gemv:
  ds_read_b64 v[64:65], v11 offset:0
  ds_read_b64 v[66:67], v11 offset:512
  ds_read_b64 v[68:69], v11 offset:1024
  ds_read_b64 v[70:71], v11 offset:1536
  buffer_store_dwordx4 v[82:85], v9, s[24:27], 0 offen sc1
  buffer_store_dword v86, v10, s[24:27], 0 offen sc1
  s_waitcnt lgkmcnt(2)
  v_pk_add_f32 v[64:65], v[64:65], v[110:111]
  v_pk_add_f32 v[64:65], v[64:65], v[66:67]
  s_waitcnt lgkmcnt(0)
  v_pk_add_f32 v[64:65], v[64:65], v[68:69]
  v_pk_add_f32 v[64:65], v[64:65], v[70:71]
  v_cvt_pk_bf16_f32 v88, v64, v65
  s_nop 1
  v_mov_b32_dpp v89, v88 row_shl:1 row_mask:0xf bank_mask:0xf
  v_mov_b32_dpp v90, v88 row_shl:2 row_mask:0xf bank_mask:0xf
  v_mov_b32_dpp v91, v88 row_shl:3 row_mask:0xf bank_mask:0xf
  v_mov_b32_dpp v92, v88 row_shl:8 row_mask:0xf bank_mask:0xf
  v_mov_b32_dpp v93, v88 row_shl:9 row_mask:0xf bank_mask:0xf
  v_smfmac_f32_16x16x64_bf16 v[16:19], v[88:91], v[112:119], v96
  v_mov_b32_dpp v94, v88 row_shl:10 row_mask:0xf bank_mask:0xf
  v_smfmac_f32_16x16x64_bf16 v[20:23], v[88:91], v[120:127], v96
  v_mov_b32_dpp v95, v88 row_shl:11 row_mask:0xf bank_mask:0xf
  v_smfmac_f32_16x16x64_bf16 v[24:27], v[88:91], v[128:135], v96
  v_smfmac_f32_16x16x64_bf16 v[28:31], v[88:91], v[136:143], v96
  v_smfmac_f32_16x16x64_bf16 v[32:35], v[88:91], v[144:151], v96
  v_smfmac_f32_16x16x64_bf16 v[36:39], v[88:91], v[152:159], v96
  v_smfmac_f32_16x16x64_bf16 v[40:43], v[88:91], v[160:167], v96
  v_smfmac_f32_16x16x64_bf16 v[44:47], v[88:91], v[168:175], v96
  v_smfmac_f32_16x16x64_bf16 v[48:51], v[88:91], v[176:183], v96
  v_smfmac_f32_16x16x64_bf16 v[48:51], v[92:95], v[248:255], v96
  v_smfmac_f32_16x16x64_bf16 v[16:19], v[92:95], v[184:191], v96
  v_smfmac_f32_16x16x64_bf16 v[32:35], v[92:95], v[216:223], v96
  v_smfmac_f32_16x16x64_bf16 v[20:23], v[92:95], v[192:199], v96
  v_smfmac_f32_16x16x64_bf16 v[36:39], v[92:95], v[224:231], v96
  v_smfmac_f32_16x16x64_bf16 v[24:27], v[92:95], v[200:207], v96
  v_smfmac_f32_16x16x64_bf16 v[40:43], v[92:95], v[232:239], v96
  v_smfmac_f32_16x16x64_bf16 v[28:31], v[92:95], v[208:215], v96
  v_smfmac_f32_16x16x64_bf16 v[44:47], v[92:95], v[240:247], v96
  s_nop 3
  v_permlane16_swap_b32 v48, v49
  v_add_f32 v48, v48, v49
  buffer_store_dword v48, v10, s[24:27], 0 offen offset:2304 sc1
  v_permlane16_swap_b32 v16, v32
  v_add_f32 v68, v16, v32
  v_permlane16_swap_b32 v20, v36
  v_add_f32 v69, v20, v36
  v_permlane16_swap_b32 v24, v40
  v_add_f32 v70, v24, v40
  v_permlane16_swap_b32 v28, v44
  v_add_f32 v71, v28, v44
  buffer_store_dwordx4 v[68:71], v9, s[24:27], 0 offen offset:2304 sc1
  s_setpc_b64 s[62:63]
L_sub_final:
  buffer_load_dwordx4 v[32:35], v15, s[12:15], 0 offen offset:0 sc1
  buffer_load_dwordx4 v[36:39], v15, s[12:15], s65 offen offset:0 sc1
  buffer_load_dwordx4 v[40:43], v15, s[12:15], s66 offen offset:0 sc1
  buffer_load_dwordx4 v[44:47], v15, s[12:15], s67 offen offset:0 sc1
  buffer_load_dwordx4 v[48:51], v15, s[12:15], 0 offen offset:2304 sc1
  buffer_load_dwordx4 v[52:55], v15, s[12:15], s65 offen offset:2304 sc1
  buffer_load_dwordx4 v[56:59], v15, s[12:15], s66 offen offset:2304 sc1
  buffer_load_dwordx4 v[60:63], v15, s[12:15], s67 offen offset:2304 sc1
  s_waitcnt vmcnt(4)
L_f_g:
  v_pk_add_f32 v[88:89], v[32:33], v[36:37]
  v_pk_add_f32 v[92:93], v[40:41], v[44:45]
  v_pk_add_f32 v[90:91], v[34:35], v[38:39]
  v_pk_add_f32 v[94:95], v[42:43], v[46:47]
  v_pk_add_f32 v[88:89], v[88:89], v[92:93]
  v_pk_add_f32 v[90:91], v[90:91], v[94:95]
  s_nop 0
  v_permlane32_swap_b32 v88, v89
  v_permlane32_swap_b32 v90, v91
  v_add_f32 v88, v88, v89
  v_add_f32 v90, v90, v91
  s_nop 1
  v_permlane16_swap_b32 v88, v90
  v_add_f32 v88, v88, v90
  s_nop 1
  v_add_f32_dpp v88, v88, v88 row_ror:8 row_mask:0xf bank_mask:0xf
  v_cmp_u_f32 vcc, v88, v88
  v_cvt_pk_bf16_f32 v88, v88, v88
  v_and_b32 v88, 0xffff0000, v88
  s_cbranch_vccnz L_f_g_again
L_f_gate:
  v_add_f32 v105, v88, v12
  v_cvt_pk_bf16_f32 v105, v105, v105
  v_and_b32 v105, 0xffff0000, v105
  v_mul_f32 v104, 0xbfb8aa3b, v105
  v_exp_f32 v104, v104
  s_nop 0
  v_add_f32 v104, 1.0, v104
  v_rcp_f32 v104, v104
  s_nop 0
  v_mul_f32 v105, v105, v104
  v_cvt_pk_bf16_f32 v105, v105, v105
  v_and_b32 v105, 0xffff0000, v105
L_f_y:
  s_waitcnt vmcnt(0)
  v_pk_add_f32 v[88:89], v[48:49], v[52:53]
  v_pk_add_f32 v[92:93], v[56:57], v[60:61]
  v_pk_add_f32 v[90:91], v[50:51], v[54:55]
  v_pk_add_f32 v[94:95], v[58:59], v[62:63]
  v_pk_add_f32 v[88:89], v[88:89], v[92:93]
  v_pk_add_f32 v[90:91], v[90:91], v[94:95]
  s_nop 0
  v_permlane32_swap_b32 v88, v89
  v_permlane32_swap_b32 v90, v91
  v_add_f32 v88, v88, v89
  v_add_f32 v90, v90, v91
  s_nop 1
  v_permlane16_swap_b32 v88, v90
  v_add_f32 v88, v88, v90
  s_nop 1
  v_add_f32_dpp v88, v88, v88 row_ror:8 row_mask:0xf bank_mask:0xf
  v_cmp_u_f32 vcc, v88, v88
  v_cvt_pk_bf16_f32 v88, v88, v88
  v_and_b32 v88, 0xffff0000, v88
  s_cbranch_vccnz L_f_y_again
L_f_out:
  v_mul_f32 v104, v88, v105
  v_cvt_pk_bf16_f32 v104, v104, v104
  v_and_b32 v104, 0xffff0000, v104
  v_add_f32 v104, v104, v13
  v_cvt_pk_bf16_f32 v104, v104, v104
  buffer_store_short v104, v14, s[16:19], s68 offen sc0 sc1
  s_setpc_b64 s[62:63]
L_f_y_again:
  v_max3_u32 v96, v48, v49, v50
  v_max3_u32 v97, v52, v53, v54
  v_max3_u32 v98, v56, v57, v58
  v_max3_u32 v99, v60, v61, v62
  v_max_u32 v96, v96, v51
  v_max_u32 v97, v97, v55
  v_max_u32 v98, v98, v59
  v_max_u32 v99, v99, v63
  v_cmp_eq_u32 s[80:81], -1, v96
  v_cmp_eq_u32 s[82:83], -1, v97
  v_cmp_eq_u32 s[84:85], -1, v98
  v_cmp_eq_u32 s[86:87], -1, v99
  s_or_b64 s[88:89], s[80:81], s[82:83]
  s_or_b64 s[90:91], s[84:85], s[86:87]
  s_or_b64 s[88:89], s[88:89], s[90:91]
  s_cbranch_scc0 L_f_out
  s_mov_b64 exec, s[80:81]
  s_cbranch_execz L_fy0
  buffer_load_dwordx4 v[48:51], v15, s[12:15], 0 offen offset:2304 sc1
L_fy0:
  s_mov_b64 exec, s[82:83]
  s_cbranch_execz L_fy1
  buffer_load_dwordx4 v[52:55], v15, s[12:15], s65 offen offset:2304 sc1
L_fy1:
  s_mov_b64 exec, s[84:85]
  s_cbranch_execz L_fy2
  buffer_load_dwordx4 v[56:59], v15, s[12:15], s66 offen offset:2304 sc1
L_fy2:
  s_mov_b64 exec, s[86:87]
  s_cbranch_execz L_fy3
  buffer_load_dwordx4 v[60:63], v15, s[12:15], s67 offen offset:2304 sc1
L_fy3:
  s_mov_b64 exec, -1
  s_sub_u32 s69, s69, 4
  s_cbranch_scc0 L_f_y
  s_mov_b32 s69, 0
  s_setpc_b64 s[62:63]
L_f_g_again:
  v_max3_u32 v96, v32, v33, v34
  v_max3_u32 v97, v36, v37, v38
  v_max3_u32 v98, v40, v41, v42
  v_max3_u32 v99, v44, v45, v46
  v_max_u32 v96, v96, v35
  v_max_u32 v97, v97, v39
  v_max_u32 v98, v98, v43
  v_max_u32 v99, v99, v47
  v_cmp_eq_u32 s[80:81], -1, v96
  v_cmp_eq_u32 s[82:83], -1, v97
  v_cmp_eq_u32 s[84:85], -1, v98
  v_cmp_eq_u32 s[86:87], -1, v99
  s_or_b64 s[88:89], s[80:81], s[82:83]
  s_or_b64 s[90:91], s[84:85], s[86:87]
  s_or_b64 s[88:89], s[88:89], s[90:91]
  s_cbranch_scc0 L_f_gate
  s_mov_b64 exec, s[80:81]
  s_cbranch_execz L_fg0
  buffer_load_dwordx4 v[32:35], v15, s[12:15], 0 offen offset:0 sc1
L_fg0:
  s_mov_b64 exec, s[82:83]
  s_cbranch_execz L_fg1
  buffer_load_dwordx4 v[36:39], v15, s[12:15], s65 offen offset:0 sc1
L_fg1:
  s_mov_b64 exec, s[84:85]
  s_cbranch_execz L_fg2
  buffer_load_dwordx4 v[40:43], v15, s[12:15], s66 offen offset:0 sc1
L_fg2:
  s_mov_b64 exec, s[86:87]
  s_cbranch_execz L_fg3
  buffer_load_dwordx4 v[44:47], v15, s[12:15], s67 offen offset:0 sc1
L_fg3:
  s_mov_b64 exec, -1
  s_waitcnt vmcnt(0)
  s_sub_u32 s69, s69, 4
  s_cbranch_scc0 L_f_g
  s_mov_b32 s69, 0
  s_setpc_b64 s[62:63]
L_streamer:
  v_and_b32 v2, 63, v0
  v_lshlrev_b32 v3, 4, v2
  v_and_b32 v7, 1, v1
  v_lshl_add_u32 v3, v7, 16, v3
  v_bfe_u32 v7, v1, 1, 1
  v_lshl_add_u32 v3, v7, 13, v3
  s_and_b32 s78, s2, 240
  s_bfe_u32 s3, s2, 196608
  s_lshl_b32 s3, s3, 1
  s_or_b32 s78, s78, s3
  s_bfe_u32 s3, s2, 65539
  s_or_b32 s78, s78, s3
  s_mov_b32 s69, 0x200000
  s_lshl_b32 s3, s78, 20
  s_barrier
  s_add_u32 s16, s38, s3
  s_addc_u32 s17, s39, 0
  s_mov_b32 s18, 0x100000
  s_mov_b32 s19, 0x20000
  s_add_u32 s12, s40, s3
  s_addc_u32 s13, s41, 0
  s_mov_b32 s14, 0x100000
  s_mov_b32 s15, 0x20000
  s_mov_b32 s37, 16384
  s_mov_b32 s38, 524288
  s_mov_b32 s39, 540672
  v_mov_b32 v188, 131072
  v_mov_b32 v189, v3
  s_mov_b64 s[6:7], s[56:57]
  s_lshr_b32 s34, s2, 5
  s_and_b32 s3, s2, 7
  s_lshl_b32 s3, s3, 2
  s_bfe_u32 s33, s2, 0x20003
  s_add_u32 s3, s3, s33
  s_mul_i32 s3, s3, 165888
  s_mul_i32 s35, s34, 20736
  s_add_u32 s3, s3, s35
  s_add_u32 s24, s52, s3
  s_addc_u32 s25, s53, 0
  s_mov_b32 s26, 20736
  s_mov_b32 s27, 0x20000
  s_and_b32 s3, s2, 7
  s_mul_i32 s3, s3, 1152
  s_lshr_b32 s33, s2, 3
  s_mul_i32 s33, s33, 165888
  s_add_u32 s3, s3, s33
  s_add_u32 s64, s48, s3
  s_addc_u32 s65, s49, 0
  s_mov_b32 s66, 157824
  s_mov_b32 s67, 0x20000
  s_mov_b32 s29, 0
  s_mov_b32 s40, 0x22222222
  s_mov_b32 s41, 0x22222222
  s_mov_b32 s42, 0x44444444
  s_mov_b32 s43, 0x44444444
  s_mov_b32 s44, 0x88888888
  s_mov_b32 s45, 0x88888888
  s_lshr_b32 s3, s2, 5
  s_and_b32 s54, s2, 31
  s_xor_b32 s54, s54, 8
  s_lshl_b32 s35, s28, 7
  s_cmp_eq_u32 s54, s3
  s_cselect_b32 s54, s35, -1
  s_mul_i32 s3, s3, 5120
  s_add_u32 s3, s3, 2097152
  s_add_u32 s20, s60, s3
  s_addc_u32 s21, s61, 0
  s_movk_i32 s22, 5120
  s_mov_b32 s23, 0x20000
  s_add_u32 s46, s60, 2097024
  s_addc_u32 s47, s61, 0
  s_mov_b32 s48, 0
  v_and_b32 v178, 15, v2
  v_lshl_add_u32 v179, v178, 4, v188
  v_and_b32 v176, 4, v178
  v_lshlrev_b32 v176, 2, v176
  v_mov_b32 v177, 0xffff
  v_lshlrev_b32 v176, v176, v177
  v_and_b32 v177, 3, v178
  v_lshrrev_b32 v32, 3, v178
  v_lshl_add_u32 v177, v177, 1, v32
  v_cmp_eq_u32 vcc, 0, v177
  s_nop 1
  v_cndmask_b32 v32, 0, v176, vcc
  v_cmp_eq_u32 vcc, 1, v177
  s_nop 1
  v_cndmask_b32 v33, 0, v176, vcc
  v_cmp_eq_u32 vcc, 2, v177
  s_nop 1
  v_cndmask_b32 v34, 0, v176, vcc
  v_cmp_eq_u32 vcc, 3, v177
  s_nop 1
  v_cndmask_b32 v35, 0, v176, vcc
  v_mov_b32 v44, 0
  v_mov_b32 v45, 0
  v_mov_b32 v46, 0
  v_mov_b32 v47, 0
  v_lshlrev_b32 v180, 4, v0
  s_movk_i32 s3, 0
  s_waitcnt vmcnt(5)
  buffer_load_dwordx4 v[132:135], v180, s[24:27], s3 offen
  s_movk_i32 s3, 4096
  s_waitcnt vmcnt(4)
  buffer_load_dwordx4 v[136:139], v180, s[24:27], s3 offen
  s_movk_i32 s3, 8192
  s_waitcnt vmcnt(5)
  buffer_load_dwordx4 v[140:143], v180, s[24:27], s3 offen
  s_movk_i32 s3, 12288
  s_waitcnt vmcnt(4)
  buffer_load_dwordx4 v[144:147], v180, s[24:27], s3 offen
  s_movk_i32 s3, 16384
  s_waitcnt vmcnt(5)
  buffer_load_dwordx4 v[148:151], v180, s[24:27], s3 offen
  s_movk_i32 s3, 20480
  s_waitcnt vmcnt(4)
  buffer_load_dwordx4 v[152:155], v180, s[24:27], s3 offen
  v_add_u32 v180, 0, v0
  v_mul_u32_u24 v181, 58255, v180
  v_lshrrev_b32 v181, 22, v181
  v_mul_u32_u24 v181, 8064, v181
  v_lshl_add_u32 v180, v180, 4, v181
  s_waitcnt vmcnt(5)
  buffer_load_dwordx4 v[112:115], v180, s[64:67], 0 offen
  v_add_u32 v180, 256, v0
  v_mul_u32_u24 v181, 58255, v180
  v_lshrrev_b32 v181, 22, v181
  v_mul_u32_u24 v181, 8064, v181
  v_lshl_add_u32 v180, v180, 4, v181
  s_waitcnt vmcnt(4)
  buffer_load_dwordx4 v[116:119], v180, s[64:67], 0 offen
  v_add_u32 v180, 512, v0
  v_mul_u32_u24 v181, 58255, v180
  v_lshrrev_b32 v181, 22, v181
  v_mul_u32_u24 v181, 8064, v181
  v_lshl_add_u32 v180, v180, 4, v181
  s_waitcnt vmcnt(5)
  buffer_load_dwordx4 v[120:123], v180, s[64:67], 0 offen
  v_add_u32 v180, 768, v0
  v_mul_u32_u24 v181, 58255, v180
  v_lshrrev_b32 v181, 22, v181
  v_mul_u32_u24 v181, 8064, v181
  v_lshl_add_u32 v180, v180, 4, v181
  s_waitcnt vmcnt(4)
  buffer_load_dwordx4 v[124:127], v180, s[64:67], 0 offen
  s_memrealtime s[50:51]
  v_add_u32 v180, 1024, v0
  v_mul_u32_u24 v181, 58255, v180
  v_lshrrev_b32 v181, 22, v181
  v_mul_u32_u24 v181, 8064, v181
  v_lshl_add_u32 v180, v180, 4, v181
  s_waitcnt vmcnt(5)
  buffer_load_dwordx4 v[128:131], v180, s[64:67], 0 offen
  s_waitcnt lgkmcnt(0)
  s_mov_b32 s49, s50
  s_mov_b32 s52, s50
  s_mov_b32 s53, s50
  s_mov_b32 s56, s50
  s_mov_b32 s57, s50
  s_add_u32 s49, s49, 0x40000000
  s_mov_b32 s92, 920
  s_mov_b32 s4, -15
  s_mov_b32 s5, 60
  v_xor_b32 v180, 397312, v3
  s_lshl_b32 s33, s28, 15
  s_mov_b32 s35, 2
L_vdma:
  s_waitcnt lgkmcnt(0)
  s_sub_u32 s79, s50, s49
  s_add_u32 s93, s79, 1500
  s_cmp_lt_u32 s93, 3000
  s_cselect_b32 s79, s79, -15
  s_cmp_ge_i32 s79, 25
  s_cselect_b64 vcc, -1, 0
  s_cselect_b32 s93, s5, s4
  s_cmp_ge_i32 s79, s93
  s_cselect_b32 s90, 1, 0
  s_mov_b32 m0, s33
  s_cbranch_vccnz L_eva0
  s_cbranch_scc1 L_evb0
  s_waitcnt vmcnt(4)
  s_cmp_lt_i32 s79, -45
  s_cbranch_scc0 L_evb0
  s_waitcnt vmcnt(3)
  s_cmp_lg_u32 s90, 0
L_evb0:
  s_waitcnt vmcnt(4)
L_eva0:
  s_cbranch_scc1 L_evc0
  s_waitcnt vmcnt(5)
L_evc0:
  s_waitcnt vmcnt(7)
  buffer_load_dwordx4 v180, s[12:15], 0 offen offset:0 nt lds
  s_and_b32 s93, s48, 384
  s_cmp_lg_u32 s54, s93
  s_cbranch_scc1 L_ck1_nopub
  v_mov_b32 v187, s50
  s_mov_b64 exec, 1
  buffer_store_dword v187, off, s[20:23], s48 sc1
  s_mov_b64 exec, -1
L_ck1_nopub:
  s_cmp_lg_u32 s90, 0
  s_cbranch_vccnz L_eva1
  s_cbranch_scc1 L_evb1
  s_waitcnt vmcnt(4)
  s_cmp_lt_i32 s79, -45
  s_cbranch_scc0 L_evb1
  s_waitcnt vmcnt(3)
  s_cmp_lg_u32 s90, 0
L_evb1:
  s_waitcnt vmcnt(5)
L_eva1:
  s_cbranch_scc1 L_evc1
  s_waitcnt vmcnt(6)
L_evc1:
  s_waitcnt vmcnt(7)
  buffer_load_dwordx4 v180, s[12:15], 0 offen offset:1024 nt lds
  s_add_u32 s88, s46, s48
  s_addc_u32 s89, s47, 0
  s_cmp_lt_u32 s48, 128
  s_cbranch_scc1 L_ck1_early
  s_load_dword s80, s[88:89], 0
  s_load_dword s81, s[88:89], 5120
  s_load_dword s82, s[88:89], 10240
  s_load_dword s83, s[88:89], 15360
  s_load_dword s84, s[88:89], 20480
  s_load_dword s85, s[88:89], 25600
  s_load_dword s86, s[88:89], 30720
  s_load_dword s87, s[88:89], 35840
L_ck1_early:
  s_cmp_lg_u32 s90, 0
  s_cbranch_vccnz L_eva2
  s_cbranch_scc1 L_evb2
  s_waitcnt vmcnt(4)
  s_cmp_lt_i32 s79, -45
  s_cbranch_scc0 L_evb2
  s_waitcnt vmcnt(3)
  s_cmp_lg_u32 s90, 0
L_evb2:
  s_waitcnt vmcnt(4)
L_eva2:
  s_cbranch_scc1 L_evc2
  s_waitcnt vmcnt(5)
L_evc2:
  s_waitcnt vmcnt(7)
  buffer_load_dwordx4 v180, s[12:15], 0 offen offset:2048 nt lds
  s_add_u32 s33, s33, 4096
  s_cmp_lg_u32 s90, 0
  s_cbranch_vccnz L_eva3
  s_cbranch_scc1 L_evb3
  s_waitcnt vmcnt(4)
  s_cmp_lt_i32 s79, -45
  s_cbranch_scc0 L_evb3
  s_waitcnt vmcnt(3)
  s_cmp_lg_u32 s90, 0
L_evb3:
  s_waitcnt vmcnt(5)
L_eva3:
  s_cbranch_scc1 L_evc3
  s_waitcnt vmcnt(6)
L_evc3:
  s_waitcnt vmcnt(7)
  buffer_load_dwordx4 v180, s[12:15], 0 offen offset:3072 nt lds
  s_mov_b32 m0, s33
  s_cbranch_vccnz L_eva4
  s_cbranch_scc1 L_evb4
  s_waitcnt vmcnt(4)
  s_cmp_lt_i32 s79, -45
  s_cbranch_scc0 L_evb4
  s_waitcnt vmcnt(3)
  s_cmp_lg_u32 s90, 0
L_evb4:
  s_waitcnt vmcnt(4)
L_eva4:
  s_cbranch_scc1 L_evc4
  s_waitcnt vmcnt(5)
L_evc4:
  s_waitcnt vmcnt(7)
  buffer_load_dwordx4 v180, s[12:15], s37 offen offset:0 nt lds
  s_cbranch_vccnz L_eva5
  s_cbranch_scc1 L_evb5
  s_waitcnt vmcnt(4)
  s_cmp_lt_i32 s79, -45
  s_cbranch_scc0 L_evb5
  s_waitcnt vmcnt(3)
  s_cmp_lg_u32 s90, 0
L_evb5:
  s_waitcnt vmcnt(5)
L_eva5:
  s_cbranch_scc1 L_evc5
  s_waitcnt vmcnt(6)
L_evc5:
  s_waitcnt vmcnt(7)
  buffer_load_dwordx4 v180, s[12:15], s37 offen offset:1024 nt lds
  s_add_u32 s33, s33, 4096
  s_cmp_lg_u32 s90, 0
  s_cbranch_vccnz L_eva6
  s_cbranch_scc1 L_evb6
  s_waitcnt vmcnt(4)
  s_cmp_lt_i32 s79, -45
  s_cbranch_scc0 L_evb6
  s_waitcnt vmcnt(3)
  s_cmp_lg_u32 s90, 0
L_evb6:
  s_waitcnt vmcnt(4)
L_eva6:
  s_cbranch_scc1 L_evc6
  s_waitcnt vmcnt(5)
L_evc6:
  s_waitcnt vmcnt(7)
  buffer_load_dwordx4 v180, s[12:15], s37 offen offset:2048 nt lds
  s_memrealtime s[98:99]
  s_lshr_b32 s93, s92, 3
  s_add_u32 s49, s49, s93
  s_cmp_lg_u32 s90, 0
  s_cbranch_vccnz L_eva7
  s_cbranch_scc1 L_evb7
  s_waitcnt vmcnt(4)
  s_cmp_lt_i32 s79, -45
  s_cbranch_scc0 L_evb7
  s_waitcnt vmcnt(3)
  s_cmp_lg_u32 s90, 0
L_evb7:
  s_waitcnt vmcnt(5)
L_eva7:
  s_cbranch_scc1 L_evc7
  s_waitcnt vmcnt(6)
L_evc7:
  s_waitcnt vmcnt(7)
  buffer_load_dwordx4 v180, s[12:15], s37 offen offset:3072 nt lds
  s_waitcnt lgkmcnt(0)
  s_sub_u32 s79, s98, s49
  s_add_u32 s93, s79, 1500
  s_cmp_lt_u32 s93, 3000
  s_cselect_b32 s79, s79, -15
  s_cmp_ge_i32 s79, 25
  s_cselect_b64 vcc, -1, 0
  s_cselect_b32 s93, s5, s4
  s_cmp_ge_i32 s79, s93
  s_cselect_b32 s90, 1, 0
  s_cmp_lg_u32 s90, 0
  s_mov_b32 m0, s33
  s_cbranch_vccnz L_eva8
  s_cbranch_scc1 L_evb8
  s_waitcnt vmcnt(4)
  s_cmp_lt_i32 s79, -45
  s_cbranch_scc0 L_evb8
  s_waitcnt vmcnt(3)
  s_cmp_lg_u32 s90, 0
L_evb8:
  s_waitcnt vmcnt(4)
L_eva8:
  s_cbranch_scc1 L_evc8
  s_waitcnt vmcnt(5)
L_evc8:
  s_waitcnt vmcnt(7)
  buffer_load_dwordx4 v180, s[12:15], s38 offen offset:0 nt lds
  s_add_u32 s91, s50, 64
  s_sub_u32 s80, s91, s80
  s_cmp_lt_u32 s80, 2500
  s_cselect_b32 s80, s80, 0
  s_sub_u32 s81, s91, s81
  s_cmp_lt_u32 s81, 2500
  s_cselect_b32 s81, s81, 0
  s_add_u32 s80, s80, s81
  s_cmp_lg_u32 s90, 0
  s_cbranch_vccnz L_eva9
  s_cbranch_scc1 L_evb9
  s_waitcnt vmcnt(4)
  s_cmp_lt_i32 s79, -45
  s_cbranch_scc0 L_evb9
  s_waitcnt vmcnt(3)
  s_cmp_lg_u32 s90, 0
L_evb9:
  s_waitcnt vmcnt(5)
L_eva9:
  s_cbranch_scc1 L_evc9
  s_waitcnt vmcnt(6)
L_evc9:
  s_waitcnt vmcnt(7)
  buffer_load_dwordx4 v180, s[12:15], s38 offen offset:1024 nt lds
  s_sub_u32 s82, s91, s82
  s_cmp_lt_u32 s82, 2500
  s_cselect_b32 s82, s82, 0
  s_add_u32 s80, s80, s82
  s_sub_u32 s83, s91, s83
  s_cmp_lt_u32 s83, 2500
  s_cselect_b32 s83, s83, 0
  s_add_u32 s80, s80, s83
  s_add_u32 s33, s33, 4096
  s_cmp_lg_u32 s90, 0
  s_cbranch_vccnz L_eva10
  s_cbranch_scc1 L_evb10
  s_waitcnt vmcnt(4)
  s_cmp_lt_i32 s79, -45
  s_cbranch_scc0 L_evb10
  s_waitcnt vmcnt(3)
  s_cmp_lg_u32 s90, 0
L_evb10:
  s_waitcnt vmcnt(4)
L_eva10:
  s_cbranch_scc1 L_evc10
  s_waitcnt vmcnt(5)
L_evc10:
  s_waitcnt vmcnt(7)
  buffer_load_dwordx4 v180, s[12:15], s38 offen offset:2048 nt lds
  s_sub_u32 s84, s91, s84
  s_cmp_lt_u32 s84, 2500
  s_cselect_b32 s84, s84, 0
  s_add_u32 s80, s80, s84
  s_sub_u32 s85, s91, s85
  s_cmp_lt_u32 s85, 2500
  s_cselect_b32 s85, s85, 0
  s_add_u32 s80, s80, s85
  s_cmp_lg_u32 s90, 0
  s_cbranch_vccnz L_eva11
  s_cbranch_scc1 L_evb11
  s_waitcnt vmcnt(4)
  s_cmp_lt_i32 s79, -45
  s_cbranch_scc0 L_evb11
  s_waitcnt vmcnt(3)
  s_cmp_lg_u32 s90, 0
L_evb11:
  s_waitcnt vmcnt(5)
L_eva11:
  s_cbranch_scc1 L_evc11
  s_waitcnt vmcnt(6)
L_evc11:
  s_waitcnt vmcnt(7)
  buffer_load_dwordx4 v180, s[12:15], s38 offen offset:3072 nt lds
  s_sub_u32 s86, s91, s86
  s_cmp_lt_u32 s86, 2500
  s_cselect_b32 s86, s86, 0
  s_add_u32 s80, s80, s86
  s_sub_u32 s87, s91, s87
  s_cmp_lt_u32 s87, 2500
  s_cselect_b32 s87, s87, 0
  s_add_u32 s80, s80, s87
  s_lshr_b32 s55, s80, 3
  s_sub_u32 s55, s91, s55
  s_cmp_lg_u32 s90, 0
  s_mov_b32 m0, s33
  s_cbranch_vccnz L_eva12
  s_cbranch_scc1 L_evb12
  s_waitcnt vmcnt(4)
  s_cmp_lt_i32 s79, -45
  s_cbranch_scc0 L_evb12
  s_waitcnt vmcnt(3)
  s_cmp_lg_u32 s90, 0
L_evb12:
  s_waitcnt vmcnt(4)
L_eva12:
  s_cbranch_scc1 L_evc12
  s_waitcnt vmcnt(5)
L_evc12:
  s_waitcnt vmcnt(7)
  buffer_load_dwordx4 v180, s[12:15], s39 offen offset:0 nt lds
  s_sub_u32 s91, s55, s57
  s_add_u32 s49, s92, 3
  s_min_u32 s91, s91, s49
  s_sub_u32 s49, s92, 3
  s_max_u32 s91, s91, s49
  s_cmp_ge_u32 s48, 1280
  s_cselect_b32 s92, s91, s92
  s_mul_i32 s91, s92, 2
  s_cmp_lg_u32 s90, 0
  s_cbranch_vccnz L_eva13
  s_cbranch_scc1 L_evb13
  s_waitcnt vmcnt(4)
  s_cmp_lt_i32 s79, -45
  s_cbranch_scc0 L_evb13
  s_waitcnt vmcnt(3)
  s_cmp_lg_u32 s90, 0
L_evb13:
  s_waitcnt vmcnt(5)
L_eva13:
  s_cbranch_scc1 L_evc13
  s_waitcnt vmcnt(6)
L_evc13:
  s_waitcnt vmcnt(7)
  buffer_load_dwordx4 v180, s[12:15], s39 offen offset:1024 nt lds
  s_lshr_b32 s91, s91, 2
  s_add_u32 s49, s55, s91
  s_mov_b32 s57, s56
  s_mov_b32 s56, s53
  s_mov_b32 s53, s52
  s_mov_b32 s52, s55
  s_add_u32 s33, s33, 4096
  s_cmp_lg_u32 s90, 0
  s_cbranch_vccnz L_eva14
  s_cbranch_scc1 L_evb14
  s_waitcnt vmcnt(4)
  s_cmp_lt_i32 s79, -45
  s_cbranch_scc0 L_evb14
  s_waitcnt vmcnt(3)
  s_cmp_lg_u32 s90, 0
L_evb14:
  s_waitcnt vmcnt(4)
L_eva14:
  s_cbranch_scc1 L_evc14
  s_waitcnt vmcnt(5)
L_evc14:
  s_waitcnt vmcnt(7)
  buffer_load_dwordx4 v180, s[12:15], s39 offen offset:2048 nt lds
  s_add_u32 s91, s50, 0x40000000
  s_cmp_lt_u32 s48, 128
  s_cselect_b32 s49, s91, s49
  s_add_u32 s48, s48, 128
  s_memrealtime s[50:51]
  s_cmp_lg_u32 s90, 0
  s_cbranch_vccnz L_eva15
  s_cbranch_scc1 L_evb15
  s_waitcnt vmcnt(4)
  s_cmp_lt_i32 s79, -45
  s_cbranch_scc0 L_evb15
  s_waitcnt vmcnt(3)
  s_cmp_lg_u32 s90, 0
L_evb15:
  s_waitcnt vmcnt(5)
L_eva15:
  s_cbranch_scc1 L_evc15
  s_waitcnt vmcnt(6)
L_evc15:
  s_waitcnt vmcnt(7)
  buffer_load_dwordx4 v180, s[12:15], s39 offen offset:3072 nt lds
  v_xor_b32 v180, 32768, v180
  s_sub_u32 s35, s35, 1
  s_cmp_lg_u32 s35, 0
  s_cbranch_scc1 L_vdma
  v_xor_b32 v180, 299008, v3
  s_waitcnt lgkmcnt(0)
  s_sub_u32 s79, s50, s49
  s_add_u32 s93, s79, 1500
  s_cmp_lt_u32 s93, 3000
  s_cselect_b32 s79, s79, -15
  s_cmp_ge_i32 s79, 25
  s_cselect_b64 vcc, -1, 0
  s_cselect_b32 s93, s5, s4
  s_cmp_ge_i32 s79, s93
  s_cselect_b32 s90, 1, 0
  s_cbranch_vccnz L_era0
  s_cbranch_scc1 L_erb0
  s_waitcnt vmcnt(4)
  s_cmp_lt_i32 s79, -45
  s_cbranch_scc0 L_erb0
  s_waitcnt vmcnt(3)
  s_cmp_lg_u32 s90, 0
L_erb0:
  s_waitcnt vmcnt(4)
L_era0:
  s_cbranch_scc1 L_erc0
  s_waitcnt vmcnt(5)
L_erc0:
  s_waitcnt vmcnt(7)
  buffer_load_dwordx4 v[190:193], v180, s[12:15], 0 offen offset:0 nt
  s_and_b32 s93, s48, 384
  s_cmp_lg_u32 s54, s93
  s_cbranch_scc1 L_ck2_nopub
  v_mov_b32 v187, s50
  s_mov_b64 exec, 1
  buffer_store_dword v187, off, s[20:23], s48 sc1
  s_mov_b64 exec, -1
L_ck2_nopub:
  s_cmp_lg_u32 s90, 0
  s_cbranch_vccnz L_era1
  s_cbranch_scc1 L_erb1
  s_waitcnt vmcnt(4)
  s_cmp_lt_i32 s79, -45
  s_cbranch_scc0 L_erb1
  s_waitcnt vmcnt(3)
  s_cmp_lg_u32 s90, 0
L_erb1:
  s_waitcnt vmcnt(5)
L_era1:
  s_cbranch_scc1 L_erc1
  s_waitcnt vmcnt(6)
L_erc1:
  s_waitcnt vmcnt(7)
  buffer_load_dwordx4 v[194:197], v180, s[12:15], 0 offen offset:1024 nt
  s_add_u32 s88, s46, s48
  s_addc_u32 s89, s47, 0
  s_cmp_lt_u32 s48, 128
  s_cbranch_scc1 L_ck2_early
  s_load_dword s80, s[88:89], 0
  s_load_dword s81, s[88:89], 5120
  s_load_dword s82, s[88:89], 10240
  s_load_dword s83, s[88:89], 15360
  s_load_dword s84, s[88:89], 20480
  s_load_dword s85, s[88:89], 25600
  s_load_dword s86, s[88:89], 30720
  s_load_dword s87, s[88:89], 35840
L_ck2_early:
  s_cmp_lg_u32 s90, 0
  s_cbranch_vccnz L_era2
  s_cbranch_scc1 L_erb2
  s_waitcnt vmcnt(4)
  s_cmp_lt_i32 s79, -45
  s_cbranch_scc0 L_erb2
  s_waitcnt vmcnt(3)
  s_cmp_lg_u32 s90, 0
L_erb2:
  s_waitcnt vmcnt(4)
L_era2:
  s_cbranch_scc1 L_erc2
  s_waitcnt vmcnt(5)
L_erc2:
  s_waitcnt vmcnt(7)
  buffer_load_dwordx4 v[198:201], v180, s[12:15], 0 offen offset:2048 nt
  s_cbranch_vccnz L_era3
  s_cbranch_scc1 L_erb3
  s_waitcnt vmcnt(4)
  s_cmp_lt_i32 s79, -45
  s_cbranch_scc0 L_erb3
  s_waitcnt vmcnt(3)
  s_cmp_lg_u32 s90, 0
L_erb3:
  s_waitcnt vmcnt(5)
L_era3:
  s_cbranch_scc1 L_erc3
  s_waitcnt vmcnt(6)
L_erc3:
  s_waitcnt vmcnt(7)
  buffer_load_dwordx4 v[202:205], v180, s[12:15], 0 offen offset:3072 nt
  s_cbranch_vccnz L_era4
  s_cbranch_scc1 L_erb4
  s_waitcnt vmcnt(4)
  s_cmp_lt_i32 s79, -45
  s_cbranch_scc0 L_erb4
  s_waitcnt vmcnt(3)
  s_cmp_lg_u32 s90, 0
L_erb4:
  s_waitcnt vmcnt(4)
L_era4:
  s_cbranch_scc1 L_erc4
  s_waitcnt vmcnt(5)
L_erc4:
  s_waitcnt vmcnt(7)
  buffer_load_dwordx4 v[206:209], v180, s[12:15], s37 offen offset:0 nt
  s_cbranch_vccnz L_era5
  s_cbranch_scc1 L_erb5
  s_waitcnt vmcnt(4)
  s_cmp_lt_i32 s79, -45
  s_cbranch_scc0 L_erb5
  s_waitcnt vmcnt(3)
  s_cmp_lg_u32 s90, 0
L_erb5:
  s_waitcnt vmcnt(5)
L_era5:
  s_cbranch_scc1 L_erc5
  s_waitcnt vmcnt(6)
L_erc5:
  s_waitcnt vmcnt(7)
  buffer_load_dwordx4 v[210:213], v180, s[12:15], s37 offen offset:1024 nt
  s_cbranch_vccnz L_era6
  s_cbranch_scc1 L_erb6
  s_waitcnt vmcnt(4)
  s_cmp_lt_i32 s79, -45
  s_cbranch_scc0 L_erb6
  s_waitcnt vmcnt(3)
  s_cmp_lg_u32 s90, 0
L_erb6:
  s_waitcnt vmcnt(4)
L_era6:
  s_cbranch_scc1 L_erc6
  s_waitcnt vmcnt(5)
L_erc6:
  s_waitcnt vmcnt(7)
  buffer_load_dwordx4 v[214:217], v180, s[12:15], s37 offen offset:2048 nt
  s_memrealtime s[98:99]
  s_lshr_b32 s93, s92, 3
  s_add_u32 s49, s49, s93
  s_cmp_lg_u32 s90, 0
  s_cbranch_vccnz L_era7
  s_cbranch_scc1 L_erb7
  s_waitcnt vmcnt(4)
  s_cmp_lt_i32 s79, -45
  s_cbranch_scc0 L_erb7
  s_waitcnt vmcnt(3)
  s_cmp_lg_u32 s90, 0
L_erb7:
  s_waitcnt vmcnt(5)
L_era7:
  s_cbranch_scc1 L_erc7
  s_waitcnt vmcnt(6)
L_erc7:
  s_waitcnt vmcnt(7)
  buffer_load_dwordx4 v[218:221], v180, s[12:15], s37 offen offset:3072 nt
  s_waitcnt lgkmcnt(0)
  s_sub_u32 s79, s98, s49
  s_add_u32 s93, s79, 1500
  s_cmp_lt_u32 s93, 3000
  s_cselect_b32 s79, s79, -15
  s_cmp_ge_i32 s79, 25
  s_cselect_b64 vcc, -1, 0
  s_cselect_b32 s93, s5, s4
  s_cmp_ge_i32 s79, s93
  s_cselect_b32 s90, 1, 0
  s_cmp_lg_u32 s90, 0
  s_cbranch_vccnz L_era8
  s_cbranch_scc1 L_erb8
  s_waitcnt vmcnt(4)
  s_cmp_lt_i32 s79, -45
  s_cbranch_scc0 L_erb8
  s_waitcnt vmcnt(3)
  s_cmp_lg_u32 s90, 0
L_erb8:
  s_waitcnt vmcnt(4)
L_era8:
  s_cbranch_scc1 L_erc8
  s_waitcnt vmcnt(5)
L_erc8:
  s_waitcnt vmcnt(7)
  buffer_load_dwordx4 v[222:225], v180, s[12:15], s38 offen offset:0 nt
  s_add_u32 s91, s50, 64
  s_sub_u32 s80, s91, s80
  s_cmp_lt_u32 s80, 2500
  s_cselect_b32 s80, s80, 0
  s_sub_u32 s81, s91, s81
  s_cmp_lt_u32 s81, 2500
  s_cselect_b32 s81, s81, 0
  s_add_u32 s80, s80, s81
  s_cmp_lg_u32 s90, 0
  s_cbranch_vccnz L_era9
  s_cbranch_scc1 L_erb9
  s_waitcnt vmcnt(4)
  s_cmp_lt_i32 s79, -45
  s_cbranch_scc0 L_erb9
  s_waitcnt vmcnt(3)
  s_cmp_lg_u32 s90, 0
L_erb9:
  s_waitcnt vmcnt(5)
L_era9:
  s_cbranch_scc1 L_erc9
  s_waitcnt vmcnt(6)
L_erc9:
  s_waitcnt vmcnt(7)
  buffer_load_dwordx4 v[226:229], v180, s[12:15], s38 offen offset:1024 nt
  s_sub_u32 s82, s91, s82
  s_cmp_lt_u32 s82, 2500
  s_cselect_b32 s82, s82, 0
  s_add_u32 s80, s80, s82
  s_sub_u32 s83, s91, s83
  s_cmp_lt_u32 s83, 2500
  s_cselect_b32 s83, s83, 0
  s_add_u32 s80, s80, s83
  s_cmp_lg_u32 s90, 0
  s_cbranch_vccnz L_era10
  s_cbranch_scc1 L_erb10
  s_waitcnt vmcnt(4)
  s_cmp_lt_i32 s79, -45
  s_cbranch_scc0 L_erb10
  s_waitcnt vmcnt(3)
  s_cmp_lg_u32 s90, 0
L_erb10:
  s_waitcnt vmcnt(4)
L_era10:
  s_cbranch_scc1 L_erc10
  s_waitcnt vmcnt(5)
L_erc10:
  s_waitcnt vmcnt(7)
  buffer_load_dwordx4 v[230:233], v180, s[12:15], s38 offen offset:2048 nt
  s_sub_u32 s84, s91, s84
  s_cmp_lt_u32 s84, 2500
  s_cselect_b32 s84, s84, 0
  s_add_u32 s80, s80, s84
  s_sub_u32 s85, s91, s85
  s_cmp_lt_u32 s85, 2500
  s_cselect_b32 s85, s85, 0
  s_add_u32 s80, s80, s85
  s_cmp_lg_u32 s90, 0
  s_cbranch_vccnz L_era11
  s_cbranch_scc1 L_erb11
  s_waitcnt vmcnt(4)
  s_cmp_lt_i32 s79, -45
  s_cbranch_scc0 L_erb11
  s_waitcnt vmcnt(3)
  s_cmp_lg_u32 s90, 0
L_erb11:
  s_waitcnt vmcnt(5)
L_era11:
  s_cbranch_scc1 L_erc11
  s_waitcnt vmcnt(6)
L_erc11:
  s_waitcnt vmcnt(7)
  buffer_load_dwordx4 v[234:237], v180, s[12:15], s38 offen offset:3072 nt
  s_sub_u32 s86, s91, s86
  s_cmp_lt_u32 s86, 2500
  s_cselect_b32 s86, s86, 0
  s_add_u32 s80, s80, s86
  s_sub_u32 s87, s91, s87
  s_cmp_lt_u32 s87, 2500
  s_cselect_b32 s87, s87, 0
  s_add_u32 s80, s80, s87
  s_lshr_b32 s55, s80, 3
  s_sub_u32 s55, s91, s55
  s_cmp_lg_u32 s90, 0
  s_cbranch_vccnz L_era12
  s_cbranch_scc1 L_erb12
  s_waitcnt vmcnt(4)
  s_cmp_lt_i32 s79, -45
  s_cbranch_scc0 L_erb12
  s_waitcnt vmcnt(3)
  s_cmp_lg_u32 s90, 0
L_erb12:
  s_waitcnt vmcnt(4)
L_era12:
  s_cbranch_scc1 L_erc12
  s_waitcnt vmcnt(5)
L_erc12:
  s_waitcnt vmcnt(7)
  buffer_load_dwordx4 v[238:241], v180, s[12:15], s39 offen offset:0 nt
  s_sub_u32 s91, s55, s57
  s_add_u32 s49, s92, 3
  s_min_u32 s91, s91, s49
  s_sub_u32 s49, s92, 3
  s_max_u32 s91, s91, s49
  s_cmp_ge_u32 s48, 1280
  s_cselect_b32 s92, s91, s92
  s_mul_i32 s91, s92, 2
  s_cmp_lg_u32 s90, 0
  s_cbranch_vccnz L_era13
  s_cbranch_scc1 L_erb13
  s_waitcnt vmcnt(4)
  s_cmp_lt_i32 s79, -45
  s_cbranch_scc0 L_erb13
  s_waitcnt vmcnt(3)
  s_cmp_lg_u32 s90, 0
L_erb13:
  s_waitcnt vmcnt(5)
L_era13:
  s_cbranch_scc1 L_erc13
  s_waitcnt vmcnt(6)
L_erc13:
  s_waitcnt vmcnt(7)
  buffer_load_dwordx4 v[242:245], v180, s[12:15], s39 offen offset:1024 nt
  s_lshr_b32 s91, s91, 2
  s_add_u32 s49, s55, s91
  s_mov_b32 s57, s56
  s_mov_b32 s56, s53
  s_mov_b32 s53, s52
  s_mov_b32 s52, s55
  s_cmp_lg_u32 s90, 0
  s_cbranch_vccnz L_era14
  s_cbranch_scc1 L_erb14
  s_waitcnt vmcnt(4)
  s_cmp_lt_i32 s79, -45
  s_cbranch_scc0 L_erb14
  s_waitcnt vmcnt(3)
  s_cmp_lg_u32 s90, 0
L_erb14:
  s_waitcnt vmcnt(4)
L_era14:
  s_cbranch_scc1 L_erc14
  s_waitcnt vmcnt(5)
L_erc14:
  s_waitcnt vmcnt(7)
  buffer_load_dwordx4 v[246:249], v180, s[12:15], s39 offen offset:2048 nt
  s_add_u32 s91, s50, 0x40000000
  s_cmp_lt_u32 s48, 128
  s_cselect_b32 s49, s91, s49
  s_add_u32 s48, s48, 128
  s_memrealtime s[50:51]
  s_cmp_lg_u32 s90, 0
  s_cbranch_vccnz L_era15
  s_cbranch_scc1 L_erb15
  s_waitcnt vmcnt(4)
  s_cmp_lt_i32 s79, -45
  s_cbranch_scc0 L_erb15
  s_waitcnt vmcnt(3)
  s_cmp_lg_u32 s90, 0
L_erb15:
  s_waitcnt vmcnt(5)
L_era15:
  s_cbranch_scc1 L_erc15
  s_waitcnt vmcnt(6)
L_erc15:
  s_waitcnt vmcnt(7)
  buffer_load_dwordx4 v[250:253], v180, s[12:15], s39 offen offset:3072 nt
  s_waitcnt lgkmcnt(0)
  s_sub_u32 s79, s50, s49
  s_add_u32 s93, s79, 1500
  s_cmp_lt_u32 s93, 3000
  s_cselect_b32 s79, s79, -15
  s_cmp_ge_i32 s79, 25
  s_cselect_b64 vcc, -1, 0
  s_cselect_b32 s93, s5, s4
  s_cmp_ge_i32 s79, s93
  s_cselect_b32 s90, 1, 0
  s_cbranch_vccnz L_eka0
  s_cbranch_scc1 L_ekb0
  s_waitcnt vmcnt(4)
  s_cmp_lt_i32 s79, -45
  s_cbranch_scc0 L_ekb0
  s_waitcnt vmcnt(3)
  s_cmp_lg_u32 s90, 0
L_ekb0:
  s_waitcnt vmcnt(4)
L_eka0:
  s_cbranch_scc1 L_ekc0
  s_waitcnt vmcnt(5)
L_ekc0:
  s_waitcnt vmcnt(7)
  buffer_load_dwordx4 v[48:51], v3, s[16:19], 0 offen offset:0 nt
  s_and_b32 s93, s48, 384
  s_cmp_lg_u32 s54, s93
  s_cbranch_scc1 L_ck3_nopub
  v_mov_b32 v187, s50
  s_mov_b64 exec, 1
  buffer_store_dword v187, off, s[20:23], s48 sc1
  s_mov_b64 exec, -1
L_ck3_nopub:
  s_cmp_lg_u32 s90, 0
  s_cbranch_vccnz L_eka1
  s_cbranch_scc1 L_ekb1
  s_waitcnt vmcnt(4)
  s_cmp_lt_i32 s79, -45
  s_cbranch_scc0 L_ekb1
  s_waitcnt vmcnt(3)
  s_cmp_lg_u32 s90, 0
L_ekb1:
  s_waitcnt vmcnt(5)
L_eka1:
  s_cbranch_scc1 L_ekc1
  s_waitcnt vmcnt(6)
L_ekc1:
  s_waitcnt vmcnt(7)
  buffer_load_dwordx4 v[52:55], v3, s[16:19], 0 offen offset:1024 nt
  s_add_u32 s88, s46, s48
  s_addc_u32 s89, s47, 0
  s_cmp_lt_u32 s48, 128
  s_cbranch_scc1 L_ck3_early
  s_load_dword s80, s[88:89], 0
  s_load_dword s81, s[88:89], 5120
  s_load_dword s82, s[88:89], 10240
  s_load_dword s83, s[88:89], 15360
  s_load_dword s84, s[88:89], 20480
  s_load_dword s85, s[88:89], 25600
  s_load_dword s86, s[88:89], 30720
  s_load_dword s87, s[88:89], 35840
L_ck3_early:
  s_cmp_lg_u32 s90, 0
  s_cbranch_vccnz L_eka2
  s_cbranch_scc1 L_ekb2
  s_waitcnt vmcnt(4)
  s_cmp_lt_i32 s79, -45
  s_cbranch_scc0 L_ekb2
  s_waitcnt vmcnt(3)
  s_cmp_lg_u32 s90, 0
L_ekb2:
  s_waitcnt vmcnt(4)
L_eka2:
  s_cbranch_scc1 L_ekc2
  s_waitcnt vmcnt(5)
L_ekc2:
  s_waitcnt vmcnt(7)
  buffer_load_dwordx4 v[56:59], v3, s[16:19], 0 offen offset:2048 nt
  s_cbranch_vccnz L_eka3
  s_cbranch_scc1 L_ekb3
  s_waitcnt vmcnt(4)
  s_cmp_lt_i32 s79, -45
  s_cbranch_scc0 L_ekb3
  s_waitcnt vmcnt(3)
  s_cmp_lg_u32 s90, 0
L_ekb3:
  s_waitcnt vmcnt(5)
L_eka3:
  s_cbranch_scc1 L_ekc3
  s_waitcnt vmcnt(6)
L_ekc3:
  s_waitcnt vmcnt(7)
  buffer_load_dwordx4 v[60:63], v3, s[16:19], 0 offen offset:3072 nt
  s_cbranch_vccnz L_eka4
  s_cbranch_scc1 L_ekb4
  s_waitcnt vmcnt(4)
  s_cmp_lt_i32 s79, -45
  s_cbranch_scc0 L_ekb4
  s_waitcnt vmcnt(3)
  s_cmp_lg_u32 s90, 0
L_ekb4:
  s_waitcnt vmcnt(4)
L_eka4:
  s_cbranch_scc1 L_ekc4
  s_waitcnt vmcnt(5)
L_ekc4:
  s_waitcnt vmcnt(7)
  buffer_load_dwordx4 v[64:67], v3, s[16:19], s37 offen offset:0 nt
  s_cbranch_vccnz L_eka5
  s_cbranch_scc1 L_ekb5
  s_waitcnt vmcnt(4)
  s_cmp_lt_i32 s79, -45
  s_cbranch_scc0 L_ekb5
  s_waitcnt vmcnt(3)
  s_cmp_lg_u32 s90, 0
L_ekb5:
  s_waitcnt vmcnt(5)
L_eka5:
  s_cbranch_scc1 L_ekc5
  s_waitcnt vmcnt(6)
L_ekc5:
  s_waitcnt vmcnt(7)
  buffer_load_dwordx4 v[68:71], v3, s[16:19], s37 offen offset:1024 nt
  s_cbranch_vccnz L_eka6
  s_cbranch_scc1 L_ekb6
  s_waitcnt vmcnt(4)
  s_cmp_lt_i32 s79, -45
  s_cbranch_scc0 L_ekb6
  s_waitcnt vmcnt(3)
  s_cmp_lg_u32 s90, 0
L_ekb6:
  s_waitcnt vmcnt(4)
L_eka6:
  s_cbranch_scc1 L_ekc6
  s_waitcnt vmcnt(5)
L_ekc6:
  s_waitcnt vmcnt(7)
  buffer_load_dwordx4 v[72:75], v3, s[16:19], s37 offen offset:2048 nt
  s_memrealtime s[98:99]
  s_lshr_b32 s93, s92, 3
  s_add_u32 s49, s49, s93
  s_cmp_lg_u32 s90, 0
  s_cbranch_vccnz L_eka7
  s_cbranch_scc1 L_ekb7
  s_waitcnt vmcnt(4)
  s_cmp_lt_i32 s79, -45
  s_cbranch_scc0 L_ekb7
  s_waitcnt vmcnt(3)
  s_cmp_lg_u32 s90, 0
L_ekb7:
  s_waitcnt vmcnt(5)
L_eka7:
  s_cbranch_scc1 L_ekc7
  s_waitcnt vmcnt(6)
L_ekc7:
  s_waitcnt vmcnt(7)
  buffer_load_dwordx4 v[76:79], v3, s[16:19], s37 offen offset:3072 nt
  s_waitcnt lgkmcnt(0)
  s_sub_u32 s79, s98, s49
  s_add_u32 s93, s79, 1500
  s_cmp_lt_u32 s93, 3000
  s_cselect_b32 s79, s79, -15
  s_cmp_ge_i32 s79, 25
  s_cselect_b64 vcc, -1, 0
  s_cselect_b32 s93, s5, s4
  s_cmp_ge_i32 s79, s93
  s_cselect_b32 s90, 1, 0
  s_cmp_lg_u32 s90, 0
  s_cbranch_vccnz L_eka8
  s_cbranch_scc1 L_ekb8
  s_waitcnt vmcnt(4)
  s_cmp_lt_i32 s79, -45
  s_cbranch_scc0 L_ekb8
  s_waitcnt vmcnt(3)
  s_cmp_lg_u32 s90, 0
L_ekb8:
  s_waitcnt vmcnt(4)
L_eka8:
  s_cbranch_scc1 L_ekc8
  s_waitcnt vmcnt(5)
L_ekc8:
  s_waitcnt vmcnt(7)
  buffer_load_dwordx4 v[80:83], v3, s[16:19], s38 offen offset:0 nt
  s_add_u32 s91, s50, 64
  s_sub_u32 s80, s91, s80
  s_cmp_lt_u32 s80, 2500
  s_cselect_b32 s80, s80, 0
  s_sub_u32 s81, s91, s81
  s_cmp_lt_u32 s81, 2500
  s_cselect_b32 s81, s81, 0
  s_add_u32 s80, s80, s81
  s_cmp_lg_u32 s90, 0
  s_cbranch_vccnz L_eka9
  s_cbranch_scc1 L_ekb9
  s_waitcnt vmcnt(4)
  s_cmp_lt_i32 s79, -45
  s_cbranch_scc0 L_ekb9
  s_waitcnt vmcnt(3)
  s_cmp_lg_u32 s90, 0
L_ekb9:
  s_waitcnt vmcnt(5)
L_eka9:
  s_cbranch_scc1 L_ekc9
  s_waitcnt vmcnt(6)
L_ekc9:
  s_waitcnt vmcnt(7)
  buffer_load_dwordx4 v[84:87], v3, s[16:19], s38 offen offset:1024 nt
  s_sub_u32 s82, s91, s82
  s_cmp_lt_u32 s82, 2500
  s_cselect_b32 s82, s82, 0
  s_add_u32 s80, s80, s82
  s_sub_u32 s83, s91, s83
  s_cmp_lt_u32 s83, 2500
  s_cselect_b32 s83, s83, 0
  s_add_u32 s80, s80, s83
  s_cmp_lg_u32 s90, 0
  s_cbranch_vccnz L_eka10
  s_cbranch_scc1 L_ekb10
  s_waitcnt vmcnt(4)
  s_cmp_lt_i32 s79, -45
  s_cbranch_scc0 L_ekb10
  s_waitcnt vmcnt(3)
  s_cmp_lg_u32 s90, 0
L_ekb10:
  s_waitcnt vmcnt(4)
L_eka10:
  s_cbranch_scc1 L_ekc10
  s_waitcnt vmcnt(5)
L_ekc10:
  s_waitcnt vmcnt(7)
  buffer_load_dwordx4 v[88:91], v3, s[16:19], s38 offen offset:2048 nt
  s_sub_u32 s84, s91, s84
  s_cmp_lt_u32 s84, 2500
  s_cselect_b32 s84, s84, 0
  s_add_u32 s80, s80, s84
  s_sub_u32 s85, s91, s85
  s_cmp_lt_u32 s85, 2500
  s_cselect_b32 s85, s85, 0
  s_add_u32 s80, s80, s85
  s_cmp_lg_u32 s90, 0
  s_cbranch_vccnz L_eka11
  s_cbranch_scc1 L_ekb11
  s_waitcnt vmcnt(4)
  s_cmp_lt_i32 s79, -45
  s_cbranch_scc0 L_ekb11
  s_waitcnt vmcnt(3)
  s_cmp_lg_u32 s90, 0
L_ekb11:
  s_waitcnt vmcnt(5)
L_eka11:
  s_cbranch_scc1 L_ekc11
  s_waitcnt vmcnt(6)
L_ekc11:
  s_waitcnt vmcnt(7)
  buffer_load_dwordx4 v[92:95], v3, s[16:19], s38 offen offset:3072 nt
  s_sub_u32 s86, s91, s86
  s_cmp_lt_u32 s86, 2500
  s_cselect_b32 s86, s86, 0
  s_add_u32 s80, s80, s86
  s_sub_u32 s87, s91, s87
  s_cmp_lt_u32 s87, 2500
  s_cselect_b32 s87, s87, 0
  s_add_u32 s80, s80, s87
  s_lshr_b32 s55, s80, 3
  s_sub_u32 s55, s91, s55
  s_cmp_lg_u32 s90, 0
  s_cbranch_vccnz L_eka12
  s_cbranch_scc1 L_ekb12
  s_waitcnt vmcnt(4)
  s_cmp_lt_i32 s79, -45
  s_cbranch_scc0 L_ekb12
  s_waitcnt vmcnt(3)
  s_cmp_lg_u32 s90, 0
L_ekb12:
  s_waitcnt vmcnt(4)
L_eka12:
  s_cbranch_scc1 L_ekc12
  s_waitcnt vmcnt(5)
L_ekc12:
  s_waitcnt vmcnt(7)
  buffer_load_dwordx4 v[96:99], v3, s[16:19], s39 offen offset:0 nt
  s_sub_u32 s91, s55, s57
  s_add_u32 s49, s92, 3
  s_min_u32 s91, s91, s49
  s_sub_u32 s49, s92, 3
  s_max_u32 s91, s91, s49
  s_cmp_ge_u32 s48, 1280
  s_cselect_b32 s92, s91, s92
  s_mul_i32 s91, s92, 2
  s_cmp_lg_u32 s90, 0
  s_cbranch_vccnz L_eka13
  s_cbranch_scc1 L_ekb13
  s_waitcnt vmcnt(4)
  s_cmp_lt_i32 s79, -45
  s_cbranch_scc0 L_ekb13
  s_waitcnt vmcnt(3)
  s_cmp_lg_u32 s90, 0
L_ekb13:
  s_waitcnt vmcnt(5)
L_eka13:
  s_cbranch_scc1 L_ekc13
  s_waitcnt vmcnt(6)
L_ekc13:
  s_waitcnt vmcnt(7)
  buffer_load_dwordx4 v[100:103], v3, s[16:19], s39 offen offset:1024 nt
  s_lshr_b32 s91, s91, 2
  s_add_u32 s49, s55, s91
  s_mov_b32 s57, s56
  s_mov_b32 s56, s53
  s_mov_b32 s53, s52
  s_mov_b32 s52, s55
  s_cmp_lg_u32 s90, 0
  s_cbranch_vccnz L_eka14
  s_cbranch_scc1 L_ekb14
  s_waitcnt vmcnt(4)
  s_cmp_lt_i32 s79, -45
  s_cbranch_scc0 L_ekb14
  s_waitcnt vmcnt(3)
  s_cmp_lg_u32 s90, 0
L_ekb14:
  s_waitcnt vmcnt(4)
L_eka14:
  s_cbranch_scc1 L_ekc14
  s_waitcnt vmcnt(5)
L_ekc14:
  s_waitcnt vmcnt(7)
  buffer_load_dwordx4 v[104:107], v3, s[16:19], s39 offen offset:2048 nt
  s_add_u32 s91, s50, 0x40000000
  s_cmp_lt_u32 s48, 128
  s_cselect_b32 s49, s91, s49
  s_add_u32 s48, s48, 128
  s_memrealtime s[50:51]
  s_cmp_lg_u32 s90, 0
  s_cbranch_vccnz L_eka15
  s_cbranch_scc1 L_ekb15
  s_waitcnt vmcnt(4)
  s_cmp_lt_i32 s79, -45
  s_cbranch_scc0 L_ekb15
  s_waitcnt vmcnt(3)
  s_cmp_lg_u32 s90, 0
L_ekb15:
  s_waitcnt vmcnt(5)
L_eka15:
  s_cbranch_scc1 L_ekc15
  s_waitcnt vmcnt(6)
L_ekc15:
  s_waitcnt vmcnt(7)
  buffer_load_dwordx4 v[108:111], v3, s[16:19], s39 offen offset:3072 nt
  s_mov_b32 s92, 870
L_qwait:
  ds_read_b32 v176, v188 offset:6216
  s_waitcnt lgkmcnt(0)
  v_readfirstlane_b32 s3, v176
  s_cmp_ge_u32 s3, 1
  s_cbranch_scc1 L_qwait_ok
  s_sub_u32 s69, s69, 1
  s_cbranch_scc0 L_qwait
  s_mov_b32 s69, 0
L_qwait_ok:
  ds_read_b128 v[4:7], v179 offset:6272
  s_mov_b32 s34, 16
  s_memrealtime s[50:51]
  s_waitcnt lgkmcnt(0)
  s_sub_u32 s50, s50, 20
L_kloop:
  s_add_u32 s29, s29, 1
  s_bfe_u32 s35, s29, 65536
  s_lshl_b32 s35, s35, 15
  s_bfe_u32 s3, s29, 131073
  s_lshl_b32 s3, s3, 17
  s_or_b32 s35, s35, s3
  s_bfe_u32 s3, s29, 65539
  s_lshl_b32 s3, s3, 12
  s_or_b32 s35, s35, s3
  v_xor_b32 v3, s35, v189
  s_cmp_eq_u32 s34, 1
  s_cselect_b32 s16, s12, s16
  s_cselect_b32 s17, s13, s17
  s_waitcnt lgkmcnt(0)
  s_sub_u32 s79, s50, s49
  s_add_u32 s93, s79, 1500
  s_cmp_lt_u32 s93, 3000
  s_cselect_b32 s79, s79, -15
  s_cmp_ge_i32 s79, 25
  s_cselect_b64 vcc, -1, 0
  s_cselect_b32 s93, s5, s4
  s_cmp_ge_i32 s79, s93
  s_cselect_b32 s90, 1, 0
  v_dot2_f32_bf16 v8, v48, v4, 0
  v_dot2_f32_bf16 v8, v49, v5, v8
  v_add_f32_dpp v11, v9, v9 row_ror:8 row_mask:0xf bank_mask:0xc
  v_dot2_f32_bf16 v8, v50, v6, v8
  v_add_f32_dpp v12, v10, v10 row_half_mirror row_mask:0xf bank_mask:0x5
  v_dot2_f32_bf16 v8, v51, v7, v8
  s_cbranch_vccnz L_pka0
  s_cbranch_scc1 L_pkb0
  s_waitcnt vmcnt(4)
  s_cmp_lt_i32 s79, -45
  s_cbranch_scc0 L_pkb0
  s_waitcnt vmcnt(3)
  s_cmp_lg_u32 s90, 0
L_pkb0:
  s_waitcnt vmcnt(4)
L_pka0:
  s_cbranch_scc1 L_pkc0
  s_waitcnt vmcnt(5)
L_pkc0:
  s_waitcnt vmcnt(9)
  buffer_load_dwordx4 v[48:51], v3, s[16:19], 0 offen offset:0 nt
  v_mov_b32 v16, v17
  s_and_b32 s93, s48, 384
  s_cmp_lg_u32 s54, s93
  s_cbranch_scc1 L_ck4_nopub
  v_mov_b32 v187, s50
  s_mov_b64 exec, 1
  buffer_store_dword v187, off, s[20:23], s48 sc1
  s_mov_b64 exec, -1
L_ck4_nopub:
  s_cmp_lg_u32 s90, 0
  v_dot2_f32_bf16 v9, v52, v4, 0
  v_dot2_f32_bf16 v9, v53, v5, v9
  v_add_f32_dpp v10, v8, v8 row_ror:8 row_mask:0xf bank_mask:0x3
  v_dot2_f32_bf16 v9, v54, v6, v9
  v_add_f32_dpp v12, v11, v11 row_half_mirror row_mask:0xf bank_mask:0xa
  v_dot2_f32_bf16 v9, v55, v7, v9
  s_cbranch_vccnz L_pka1
  s_cbranch_scc1 L_pkb1
  s_waitcnt vmcnt(4)
  s_cmp_lt_i32 s79, -45
  s_cbranch_scc0 L_pkb1
  s_waitcnt vmcnt(3)
  s_cmp_lg_u32 s90, 0
L_pkb1:
  s_waitcnt vmcnt(5)
L_pka1:
  s_cbranch_scc1 L_pkc1
  s_waitcnt vmcnt(6)
L_pkc1:
  s_waitcnt vmcnt(9)
  buffer_load_dwordx4 v[52:55], v3, s[16:19], 0 offen offset:1024 nt
  v_mov_b32 v17, v18
  s_add_u32 s88, s46, s48
  s_addc_u32 s89, s47, 0
  s_cmp_lt_u32 s48, 128
  s_cbranch_scc1 L_ck4_early
  s_load_dword s80, s[88:89], 0
  s_load_dword s81, s[88:89], 5120
  s_load_dword s82, s[88:89], 10240
  s_load_dword s83, s[88:89], 15360
  s_load_dword s84, s[88:89], 20480
  s_load_dword s85, s[88:89], 25600
  s_load_dword s86, s[88:89], 30720
  s_load_dword s87, s[88:89], 35840
L_ck4_early:
  s_cmp_lg_u32 s90, 0
  v_dot2_f32_bf16 v8, v56, v4, 0
  v_dot2_f32_bf16 v8, v57, v5, v8
  v_add_f32_dpp v10, v9, v9 row_ror:8 row_mask:0xf bank_mask:0xc
  v_dot2_f32_bf16 v8, v58, v6, v8
  v_add_f32_dpp v13, v12, v12 quad_perm:[1,0,3,2] row_mask:0xf bank_mask:0xf
  v_dot2_f32_bf16 v8, v59, v7, v8
  s_cbranch_vccnz L_pka2
  s_cbranch_scc1 L_pkb2
  s_waitcnt vmcnt(4)
  s_cmp_lt_i32 s79, -45
  s_cbranch_scc0 L_pkb2
  s_waitcnt vmcnt(3)
  s_cmp_lg_u32 s90, 0
L_pkb2:
  s_waitcnt vmcnt(4)
L_pka2:
  s_cbranch_scc1 L_pkc2
  s_waitcnt vmcnt(5)
L_pkc2:
  s_waitcnt vmcnt(9)
  buffer_load_dwordx4 v[56:59], v3, s[16:19], 0 offen offset:2048 nt
  v_mov_b32 v18, v19
  v_dot2_f32_bf16 v9, v60, v4, 0
  v_dot2_f32_bf16 v9, v61, v5, v9
  v_add_f32_dpp v11, v8, v8 row_ror:8 row_mask:0xf bank_mask:0x3
  v_dot2_f32_bf16 v9, v62, v6, v9
  v_add_f32_dpp v12, v13, v13 quad_perm:[2,3,0,1] row_mask:0xf bank_mask:0xf
  v_dot2_f32_bf16 v9, v63, v7, v9
  s_cbranch_vccnz L_pka3
  s_cbranch_scc1 L_pkb3
  s_waitcnt vmcnt(4)
  s_cmp_lt_i32 s79, -45
  s_cbranch_scc0 L_pkb3
  s_waitcnt vmcnt(3)
  s_cmp_lg_u32 s90, 0
L_pkb3:
  s_waitcnt vmcnt(5)
L_pka3:
  s_cbranch_scc1 L_pkc3
  s_waitcnt vmcnt(6)
L_pkc3:
  s_waitcnt vmcnt(9)
  buffer_load_dwordx4 v[60:63], v3, s[16:19], 0 offen offset:3072 nt
  v_cndmask_b32 v14, v14, v12, s[44:45]
  v_mov_b32 v19, v20
  v_dot2_f32_bf16 v8, v64, v4, 0
  v_dot2_f32_bf16 v8, v65, v5, v8
  v_add_f32_dpp v11, v9, v9 row_ror:8 row_mask:0xf bank_mask:0xc
  v_dot2_f32_bf16 v8, v66, v6, v8
  v_add_f32_dpp v12, v10, v10 row_half_mirror row_mask:0xf bank_mask:0x5
  v_dot2_f32_bf16 v8, v67, v7, v8
  s_cbranch_vccnz L_pka4
  s_cbranch_scc1 L_pkb4
  s_waitcnt vmcnt(4)
  s_cmp_lt_i32 s79, -45
  s_cbranch_scc0 L_pkb4
  s_waitcnt vmcnt(3)
  s_cmp_lg_u32 s90, 0
L_pkb4:
  s_waitcnt vmcnt(4)
L_pka4:
  s_cbranch_scc1 L_pkc4
  s_waitcnt vmcnt(5)
L_pkc4:
  s_waitcnt vmcnt(9)
  buffer_load_dwordx4 v[64:67], v3, s[16:19], s37 offen offset:0 nt
  v_cvt_pk_bf16_f32 v14, v14, v14
  v_and_b32 v14, 0xffff0000, v14
  v_mul_f32 v14, 0x3db504f3, v14
  v_mov_b32 v20, v21
  v_dot2_f32_bf16 v9, v68, v4, 0
  v_dot2_f32_bf16 v9, v69, v5, v9
  v_add_f32_dpp v10, v8, v8 row_ror:8 row_mask:0xf bank_mask:0x3
  v_dot2_f32_bf16 v9, v70, v6, v9
  v_add_f32_dpp v12, v11, v11 row_half_mirror row_mask:0xf bank_mask:0xa
  v_dot2_f32_bf16 v9, v71, v7, v9
  s_cbranch_vccnz L_pka5
  s_cbranch_scc1 L_pkb5
  s_waitcnt vmcnt(4)
  s_cmp_lt_i32 s79, -45
  s_cbranch_scc0 L_pkb5
  s_waitcnt vmcnt(3)
  s_cmp_lg_u32 s90, 0
L_pkb5:
  s_waitcnt vmcnt(5)
L_pka5:
  s_cbranch_scc1 L_pkc5
  s_waitcnt vmcnt(6)
L_pkc5:
  s_waitcnt vmcnt(9)
  buffer_load_dwordx4 v[68:71], v3, s[16:19], s37 offen offset:1024 nt
  v_cvt_pk_bf16_f32 v31, v14, v14
  v_and_b32 v31, 0xffff0000, v31
  v_mov_b32 v21, v22
  v_dot2_f32_bf16 v8, v72, v4, 0
  v_dot2_f32_bf16 v8, v73, v5, v8
  v_add_f32_dpp v10, v9, v9 row_ror:8 row_mask:0xf bank_mask:0xc
  v_dot2_f32_bf16 v8, v74, v6, v8
  v_add_f32_dpp v13, v12, v12 quad_perm:[1,0,3,2] row_mask:0xf bank_mask:0xf
  v_dot2_f32_bf16 v8, v75, v7, v8
  s_cbranch_vccnz L_pka6
  s_cbranch_scc1 L_pkb6
  s_waitcnt vmcnt(4)
  s_cmp_lt_i32 s79, -45
  s_cbranch_scc0 L_pkb6
  s_waitcnt vmcnt(3)
  s_cmp_lg_u32 s90, 0
L_pkb6:
  s_waitcnt vmcnt(4)
L_pka6:
  s_cbranch_scc1 L_pkc6
  s_waitcnt vmcnt(5)
L_pkc6:
  s_waitcnt vmcnt(9)
  buffer_load_dwordx4 v[72:75], v3, s[16:19], s37 offen offset:2048 nt
  v_mov_b32 v22, v23
  s_memrealtime s[98:99]
  s_lshr_b32 s93, s92, 3
  s_add_u32 s49, s49, s93
  s_cmp_lg_u32 s90, 0
  v_dot2_f32_bf16 v9, v76, v4, 0
  v_dot2_f32_bf16 v9, v77, v5, v9
  v_add_f32_dpp v11, v8, v8 row_ror:8 row_mask:0xf bank_mask:0x3
  v_dot2_f32_bf16 v9, v78, v6, v9
  v_add_f32_dpp v14, v13, v13 quad_perm:[2,3,0,1] row_mask:0xf bank_mask:0xf
  v_dot2_f32_bf16 v9, v79, v7, v9
  s_cbranch_vccnz L_pka7
  s_cbranch_scc1 L_pkb7
  s_waitcnt vmcnt(4)
  s_cmp_lt_i32 s79, -45
  s_cbranch_scc0 L_pkb7
  s_waitcnt vmcnt(3)
  s_cmp_lg_u32 s90, 0
L_pkb7:
  s_waitcnt vmcnt(5)
L_pka7:
  s_cbranch_scc1 L_pkc7
  s_waitcnt vmcnt(6)
L_pkc7:
  s_waitcnt vmcnt(9)
  buffer_load_dwordx4 v[76:79], v3, s[16:19], s37 offen offset:3072 nt
  v_mov_b32 v23, v24
  s_waitcnt lgkmcnt(0)
  s_sub_u32 s79, s98, s49
  s_add_u32 s93, s79, 1500
  s_cmp_lt_u32 s93, 3000
  s_cselect_b32 s79, s79, -15
  s_cmp_ge_i32 s79, 25
  s_cselect_b64 vcc, -1, 0
  s_cselect_b32 s93, s5, s4
  s_cmp_ge_i32 s79, s93
  s_cselect_b32 s90, 1, 0
  s_cmp_lg_u32 s90, 0
  v_dot2_f32_bf16 v8, v80, v4, 0
  v_dot2_f32_bf16 v8, v81, v5, v8
  v_add_f32_dpp v11, v9, v9 row_ror:8 row_mask:0xf bank_mask:0xc
  v_dot2_f32_bf16 v8, v82, v6, v8
  v_add_f32_dpp v12, v10, v10 row_half_mirror row_mask:0xf bank_mask:0x5
  v_dot2_f32_bf16 v8, v83, v7, v8
  s_cbranch_vccnz L_pka8
  s_cbranch_scc1 L_pkb8
  s_waitcnt vmcnt(4)
  s_cmp_lt_i32 s79, -45
  s_cbranch_scc0 L_pkb8
  s_waitcnt vmcnt(3)
  s_cmp_lg_u32 s90, 0
L_pkb8:
  s_waitcnt vmcnt(4)
L_pka8:
  s_cbranch_scc1 L_pkc8
  s_waitcnt vmcnt(5)
L_pkc8:
  s_waitcnt vmcnt(9)
  buffer_load_dwordx4 v[80:83], v3, s[16:19], s38 offen offset:0 nt
  v_mov_b32 v24, v25
  s_add_u32 s91, s50, 64
  s_sub_u32 s80, s91, s80
  s_cmp_lt_u32 s80, 2500
  s_cselect_b32 s80, s80, 0
  s_sub_u32 s81, s91, s81
  s_cmp_lt_u32 s81, 2500
  s_cselect_b32 s81, s81, 0
  s_add_u32 s80, s80, s81
  s_cmp_lg_u32 s90, 0
  v_dot2_f32_bf16 v9, v84, v4, 0
  v_dot2_f32_bf16 v9, v85, v5, v9
  v_add_f32_dpp v10, v8, v8 row_ror:8 row_mask:0xf bank_mask:0x3
  v_dot2_f32_bf16 v9, v86, v6, v9
  v_add_f32_dpp v12, v11, v11 row_half_mirror row_mask:0xf bank_mask:0xa
  v_dot2_f32_bf16 v9, v87, v7, v9
  s_cbranch_vccnz L_pka9
  s_cbranch_scc1 L_pkb9
  s_waitcnt vmcnt(4)
  s_cmp_lt_i32 s79, -45
  s_cbranch_scc0 L_pkb9
  s_waitcnt vmcnt(3)
  s_cmp_lg_u32 s90, 0
L_pkb9:
  s_waitcnt vmcnt(5)
L_pka9:
  s_cbranch_scc1 L_pkc9
  s_waitcnt vmcnt(6)
L_pkc9:
  s_waitcnt vmcnt(9)
  buffer_load_dwordx4 v[84:87], v3, s[16:19], s38 offen offset:1024 nt
  v_mov_b32 v25, v26
  s_sub_u32 s82, s91, s82
  s_cmp_lt_u32 s82, 2500
  s_cselect_b32 s82, s82, 0
  s_add_u32 s80, s80, s82
  s_sub_u32 s83, s91, s83
  s_cmp_lt_u32 s83, 2500
  s_cselect_b32 s83, s83, 0
  s_add_u32 s80, s80, s83
  s_cmp_lg_u32 s90, 0
  v_dot2_f32_bf16 v8, v88, v4, 0
  v_dot2_f32_bf16 v8, v89, v5, v8
  v_add_f32_dpp v10, v9, v9 row_ror:8 row_mask:0xf bank_mask:0xc
  v_dot2_f32_bf16 v8, v90, v6, v8
  v_add_f32_dpp v13, v12, v12 quad_perm:[1,0,3,2] row_mask:0xf bank_mask:0xf
  v_dot2_f32_bf16 v8, v91, v7, v8
  s_cbranch_vccnz L_pka10
  s_cbranch_scc1 L_pkb10
  s_waitcnt vmcnt(4)
  s_cmp_lt_i32 s79, -45
  s_cbranch_scc0 L_pkb10
  s_waitcnt vmcnt(3)
  s_cmp_lg_u32 s90, 0
L_pkb10:
  s_waitcnt vmcnt(4)
L_pka10:
  s_cbranch_scc1 L_pkc10
  s_waitcnt vmcnt(5)
L_pkc10:
  s_waitcnt vmcnt(9)
  buffer_load_dwordx4 v[88:91], v3, s[16:19], s38 offen offset:2048 nt
  v_mov_b32 v26, v27
  s_sub_u32 s84, s91, s84
  s_cmp_lt_u32 s84, 2500
  s_cselect_b32 s84, s84, 0
  s_add_u32 s80, s80, s84
  s_sub_u32 s85, s91, s85
  s_cmp_lt_u32 s85, 2500
  s_cselect_b32 s85, s85, 0
  s_add_u32 s80, s80, s85
  s_cmp_lg_u32 s90, 0
  v_dot2_f32_bf16 v9, v92, v4, 0
  v_dot2_f32_bf16 v9, v93, v5, v9
  v_add_f32_dpp v11, v8, v8 row_ror:8 row_mask:0xf bank_mask:0x3
  v_dot2_f32_bf16 v9, v94, v6, v9
  v_add_f32_dpp v12, v13, v13 quad_perm:[2,3,0,1] row_mask:0xf bank_mask:0xf
  v_dot2_f32_bf16 v9, v95, v7, v9
  s_cbranch_vccnz L_pka11
  s_cbranch_scc1 L_pkb11
  s_waitcnt vmcnt(4)
  s_cmp_lt_i32 s79, -45
  s_cbranch_scc0 L_pkb11
  s_waitcnt vmcnt(3)
  s_cmp_lg_u32 s90, 0
L_pkb11:
  s_waitcnt vmcnt(5)
L_pka11:
  s_cbranch_scc1 L_pkc11
  s_waitcnt vmcnt(6)
L_pkc11:
  s_waitcnt vmcnt(9)
  buffer_load_dwordx4 v[92:95], v3, s[16:19], s38 offen offset:3072 nt
  v_cndmask_b32 v14, v14, v12, s[40:41]
  v_mov_b32 v27, v28
  s_sub_u32 s86, s91, s86
  s_cmp_lt_u32 s86, 2500
  s_cselect_b32 s86, s86, 0
  s_add_u32 s80, s80, s86
  s_sub_u32 s87, s91, s87
  s_cmp_lt_u32 s87, 2500
  s_cselect_b32 s87, s87, 0
  s_add_u32 s80, s80, s87
  s_lshr_b32 s55, s80, 3
  s_sub_u32 s55, s91, s55
  s_cmp_lg_u32 s90, 0
  v_dot2_f32_bf16 v8, v96, v4, 0
  v_dot2_f32_bf16 v8, v97, v5, v8
  v_add_f32_dpp v11, v9, v9 row_ror:8 row_mask:0xf bank_mask:0xc
  v_dot2_f32_bf16 v8, v98, v6, v8
  v_add_f32_dpp v12, v10, v10 row_half_mirror row_mask:0xf bank_mask:0x5
  v_dot2_f32_bf16 v8, v99, v7, v8
  s_cbranch_vccnz L_pka12
  s_cbranch_scc1 L_pkb12
  s_waitcnt vmcnt(4)
  s_cmp_lt_i32 s79, -45
  s_cbranch_scc0 L_pkb12
  s_waitcnt vmcnt(3)
  s_cmp_lg_u32 s90, 0
L_pkb12:
  s_waitcnt vmcnt(4)
L_pka12:
  s_cbranch_scc1 L_pkc12
  s_waitcnt vmcnt(5)
L_pkc12:
  s_waitcnt vmcnt(9)
  buffer_load_dwordx4 v[96:99], v3, s[16:19], s39 offen offset:0 nt
  v_mov_b32 v28, v29
  s_sub_u32 s91, s55, s57
  s_add_u32 s49, s92, 3
  s_min_u32 s91, s91, s49
  s_sub_u32 s49, s92, 3
  s_max_u32 s91, s91, s49
  s_cmp_ge_u32 s48, 1280
  s_cselect_b32 s92, s91, s92
  s_mul_i32 s91, s92, 2
  s_cmp_lg_u32 s90, 0
  v_dot2_f32_bf16 v9, v100, v4, 0
  v_dot2_f32_bf16 v9, v101, v5, v9
  v_add_f32_dpp v10, v8, v8 row_ror:8 row_mask:0xf bank_mask:0x3
  v_dot2_f32_bf16 v9, v102, v6, v9
  v_add_f32_dpp v12, v11, v11 row_half_mirror row_mask:0xf bank_mask:0xa
  v_dot2_f32_bf16 v9, v103, v7, v9
  s_cbranch_vccnz L_pka13
  s_cbranch_scc1 L_pkb13
  s_waitcnt vmcnt(4)
  s_cmp_lt_i32 s79, -45
  s_cbranch_scc0 L_pkb13
  s_waitcnt vmcnt(3)
  s_cmp_lg_u32 s90, 0
L_pkb13:
  s_waitcnt vmcnt(5)
L_pka13:
  s_cbranch_scc1 L_pkc13
  s_waitcnt vmcnt(6)
L_pkc13:
  s_waitcnt vmcnt(9)
  buffer_load_dwordx4 v[100:103], v3, s[16:19], s39 offen offset:1024 nt
  v_mov_b32 v29, v30
  s_lshr_b32 s91, s91, 2
  s_add_u32 s49, s55, s91
  s_mov_b32 s57, s56
  s_mov_b32 s56, s53
  s_mov_b32 s53, s52
  s_mov_b32 s52, s55
  s_cmp_lg_u32 s90, 0
  v_dot2_f32_bf16 v8, v104, v4, 0
  v_dot2_f32_bf16 v8, v105, v5, v8
  v_add_f32_dpp v10, v9, v9 row_ror:8 row_mask:0xf bank_mask:0xc
  v_dot2_f32_bf16 v8, v106, v6, v8
  v_add_f32_dpp v13, v12, v12 quad_perm:[1,0,3,2] row_mask:0xf bank_mask:0xf
  v_dot2_f32_bf16 v8, v107, v7, v8
  s_cbranch_vccnz L_pka14
  s_cbranch_scc1 L_pkb14
  s_waitcnt vmcnt(4)
  s_cmp_lt_i32 s79, -45
  s_cbranch_scc0 L_pkb14
  s_waitcnt vmcnt(3)
  s_cmp_lg_u32 s90, 0
L_pkb14:
  s_waitcnt vmcnt(4)
L_pka14:
  s_cbranch_scc1 L_pkc14
  s_waitcnt vmcnt(5)
L_pkc14:
  s_waitcnt vmcnt(9)
  buffer_load_dwordx4 v[104:107], v3, s[16:19], s39 offen offset:2048 nt
  v_mov_b32 v30, v31
  s_add_u32 s91, s50, 0x40000000
  s_cmp_lt_u32 s48, 128
  s_cselect_b32 s49, s91, s49
  s_add_u32 s48, s48, 128
  s_memrealtime s[50:51]
  s_cmp_lg_u32 s90, 0
  v_dot2_f32_bf16 v9, v108, v4, 0
  v_dot2_f32_bf16 v9, v109, v5, v9
  v_add_f32_dpp v11, v8, v8 row_ror:8 row_mask:0xf bank_mask:0x3
  v_dot2_f32_bf16 v9, v110, v6, v9
  v_add_f32_dpp v12, v13, v13 quad_perm:[2,3,0,1] row_mask:0xf bank_mask:0xf
  v_dot2_f32_bf16 v9, v111, v7, v9
  s_cbranch_vccnz L_pka15
  s_cbranch_scc1 L_pkb15
  s_waitcnt vmcnt(4)
  s_cmp_lt_i32 s79, -45
  s_cbranch_scc0 L_pkb15
  s_waitcnt vmcnt(3)
  s_cmp_lg_u32 s90, 0
L_pkb15:
  s_waitcnt vmcnt(5)
L_pka15:
  s_cbranch_scc1 L_pkc15
  s_waitcnt vmcnt(6)
L_pkc15:
  s_waitcnt vmcnt(9)
  buffer_load_dwordx4 v[108:111], v3, s[16:19], s39 offen offset:3072 nt
  v_cndmask_b32 v14, v14, v12, s[42:43]
  s_sub_u32 s34, s34, 1
  s_cmp_lg_u32 s34, 0
  s_cbranch_scc1 L_kloop
  s_add_u32 s29, s29, 1
  s_bfe_u32 s35, s29, 65536
  s_lshl_b32 s35, s35, 15
  s_bfe_u32 s3, s29, 131073
  s_lshl_b32 s3, s3, 17
  s_or_b32 s35, s35, s3
  s_bfe_u32 s3, s29, 65539
  s_lshl_b32 s3, s3, 12
  s_or_b32 s35, s35, s3
  v_xor_b32 v3, s35, v189
  s_waitcnt lgkmcnt(0)
  s_sub_u32 s79, s50, s49
  s_add_u32 s93, s79, 1500
  s_cmp_lt_u32 s93, 3000
  s_cselect_b32 s79, s79, -15
  s_cmp_ge_i32 s79, 25
  s_cselect_b64 vcc, -1, 0
  s_cselect_b32 s93, s5, s4
  s_cmp_ge_i32 s79, s93
  s_cselect_b32 s90, 1, 0
  s_cmp_lg_u32 s90, 0
  s_cbranch_vccnz L_pta0
  s_cbranch_scc1 L_ptb0
  s_waitcnt vmcnt(3)
L_ptb0:
  s_waitcnt vmcnt(4)
L_pta0:
  s_cbranch_scc1 L_ptc0
  s_waitcnt vmcnt(5)
L_ptc0:
  s_waitcnt vmcnt(9)
  buffer_load_dwordx4 v[112:115], v3, s[16:19], 0 offen offset:0 nt
  s_and_b32 s93, s48, 384
  s_cmp_lg_u32 s54, s93
  s_cbranch_scc1 L_ck5_nopub
  v_mov_b32 v187, s50
  s_mov_b64 exec, 1
  buffer_store_dword v187, off, s[20:23], s48 sc1
  s_mov_b64 exec, -1
L_ck5_nopub:
  v_add_f32_dpp v11, v9, v9 row_ror:8 row_mask:0xf bank_mask:0xc
  v_add_f32_dpp v12, v10, v10 row_half_mirror row_mask:0xf bank_mask:0x5
  s_nop 1
  v_add_f32_dpp v12, v11, v11 row_half_mirror row_mask:0xf bank_mask:0xa
  s_nop 1
  v_add_f32_dpp v13, v12, v12 quad_perm:[1,0,3,2] row_mask:0xf bank_mask:0xf
  s_nop 1
  v_add_f32_dpp v12, v13, v13 quad_perm:[2,3,0,1] row_mask:0xf bank_mask:0xf
  v_cndmask_b32 v14, v14, v12, s[44:45]
  v_cvt_pk_bf16_f32 v14, v14, v14
  v_and_b32 v14, 0xffff0000, v14
  v_mul_f32 v14, 0x3db504f3, v14
  v_cvt_pk_bf16_f32 v31, v14, v14
  v_and_b32 v31, 0xffff0000, v31
  v_max3_f32 v15, v16, v17, v18
  v_max3_f32 v15, v15, v19, v20
  v_max3_f32 v15, v15, v21, v22
  v_max3_f32 v15, v15, v23, v24
  v_max3_f32 v15, v15, v25, v26
  v_max3_f32 v15, v15, v27, v28
  v_max3_f32 v15, v15, v29, v30
  v_max_f32 v15, v15, v31
  s_cmp_lg_u32 s90, 0
  s_cbranch_vccnz L_pta1
  s_cbranch_scc1 L_ptb1
  s_waitcnt vmcnt(3)
L_ptb1:
  s_waitcnt vmcnt(4)
L_pta1:
  s_cbranch_scc1 L_ptc1
  s_waitcnt vmcnt(5)
L_ptc1:
  s_waitcnt vmcnt(9)
  buffer_load_dwordx4 v[116:119], v3, s[16:19], 0 offen offset:1024 nt
  s_add_u32 s88, s46, s48
  s_addc_u32 s89, s47, 0
  s_cmp_lt_u32 s48, 128
  s_cbranch_scc1 L_ck5_early
  s_load_dword s80, s[88:89], 0
  s_load_dword s81, s[88:89], 5120
  s_load_dword s82, s[88:89], 10240
  s_load_dword s83, s[88:89], 15360
  s_load_dword s84, s[88:89], 20480
  s_load_dword s85, s[88:89], 25600
  s_load_dword s86, s[88:89], 30720
  s_load_dword s87, s[88:89], 35840
L_ck5_early:
  s_nop 1
  v_max_f32_dpp v15, v15, v15 row_ror:8 row_mask:0xf bank_mask:0xf
  s_nop 1
  v_max_f32_dpp v15, v15, v15 row_ror:4 row_mask:0xf bank_mask:0xf
  s_nop 1
  v_max_f32_dpp v15, v15, v15 row_ror:2 row_mask:0xf bank_mask:0xf
  s_nop 1
  v_max_f32_dpp v15, v15, v15 row_ror:1 row_mask:0xf bank_mask:0xf
  v_mov_b32 v176, v15
  s_nop 1
  v_permlane16_swap_b32 v176, v15
  s_nop 1
  v_max_f32 v15, v15, v176
  v_mov_b32 v176, v15
  s_nop 1
  v_permlane32_swap_b32 v176, v15
  s_nop 1
  v_max_f32 v15, v15, v176
  v_sub_f32 v16, v16, v15
  v_sub_f32 v17, v17, v15
  v_sub_f32 v18, v18, v15
  v_sub_f32 v19, v19, v15
  s_cmp_lg_u32 s90, 0
  s_cbranch_vccnz L_pta2
  s_cbranch_scc1 L_ptb2
  s_waitcnt vmcnt(3)
L_ptb2:
  s_waitcnt vmcnt(4)
L_pta2:
  s_cbranch_scc1 L_ptc2
  s_waitcnt vmcnt(5)
L_ptc2:
  s_waitcnt vmcnt(9)
  buffer_load_dwordx4 v[120:123], v3, s[16:19], 0 offen offset:2048 nt
  v_sub_f32 v20, v20, v15
  v_sub_f32 v21, v21, v15
  v_sub_f32 v22, v22, v15
  v_sub_f32 v23, v23, v15
  v_sub_f32 v24, v24, v15
  v_sub_f32 v25, v25, v15
  v_sub_f32 v26, v26, v15
  v_sub_f32 v27, v27, v15
  v_sub_f32 v28, v28, v15
  v_sub_f32 v29, v29, v15
  v_sub_f32 v30, v30, v15
  v_sub_f32 v31, v31, v15
  v_mul_f32 v16, 0x3fb8aa3b, v16
  v_mul_f32 v17, 0x3fb8aa3b, v17
  v_mul_f32 v18, 0x3fb8aa3b, v18
  v_mul_f32 v19, 0x3fb8aa3b, v19
  v_mul_f32 v20, 0x3fb8aa3b, v20
  v_mul_f32 v21, 0x3fb8aa3b, v21
  v_mul_f32 v22, 0x3fb8aa3b, v22
  v_mul_f32 v23, 0x3fb8aa3b, v23
  v_mul_f32 v24, 0x3fb8aa3b, v24
  v_mul_f32 v25, 0x3fb8aa3b, v25
  s_cmp_lg_u32 s90, 0
  s_cbranch_vccnz L_pta3
  s_cbranch_scc1 L_ptb3
  s_waitcnt vmcnt(3)
L_ptb3:
  s_waitcnt vmcnt(4)
L_pta3:
  s_cbranch_scc1 L_ptc3
  s_waitcnt vmcnt(5)
L_ptc3:
  s_waitcnt vmcnt(9)
  buffer_load_dwordx4 v[124:127], v3, s[16:19], 0 offen offset:3072 nt
  v_mul_f32 v26, 0x3fb8aa3b, v26
  v_mul_f32 v27, 0x3fb8aa3b, v27
  v_mul_f32 v28, 0x3fb8aa3b, v28
  v_mul_f32 v29, 0x3fb8aa3b, v29
  v_mul_f32 v30, 0x3fb8aa3b, v30
  v_mul_f32 v31, 0x3fb8aa3b, v31
  v_exp_f32 v16, v16
  v_exp_f32 v17, v17
  v_exp_f32 v18, v18
  v_exp_f32 v19, v19
  v_exp_f32 v20, v20
  v_exp_f32 v21, v21
  v_exp_f32 v22, v22
  v_exp_f32 v23, v23
  v_exp_f32 v24, v24
  v_exp_f32 v25, v25
  v_exp_f32 v26, v26
  v_exp_f32 v27, v27
  v_exp_f32 v28, v28
  v_exp_f32 v29, v29
  v_exp_f32 v30, v30
  v_exp_f32 v31, v31
  s_cmp_lg_u32 s90, 0
  s_cbranch_vccnz L_pta4
  s_cbranch_scc1 L_ptb4
  s_waitcnt vmcnt(3)
L_ptb4:
  s_waitcnt vmcnt(4)
L_pta4:
  s_cbranch_scc1 L_ptc4
  s_waitcnt vmcnt(5)
L_ptc4:
  s_waitcnt vmcnt(9)
  buffer_load_dwordx4 v[128:131], v3, s[16:19], s37 offen offset:0 nt
  v_add_f32 v14, v16, v17
  v_add_f32 v14, v14, v18
  v_add_f32 v14, v14, v19
  v_add_f32 v14, v14, v20
  v_add_f32 v14, v14, v21
  v_add_f32 v14, v14, v22
  v_add_f32 v14, v14, v23
  v_add_f32 v14, v14, v24
  v_add_f32 v14, v14, v25
  v_add_f32 v14, v14, v26
  v_add_f32 v14, v14, v27
  v_add_f32 v14, v14, v28
  v_add_f32 v14, v14, v29
  v_add_f32 v14, v14, v30
  v_add_f32 v14, v14, v31
  s_lshl_b32 s3, s28, 9
  v_lshl_add_u32 v178, v2, 2, v188
  v_add_u32 v178, s3, v178
  ds_write_b32 v178, v30 offset:4096
  ds_write_b32 v178, v31 offset:4352
  s_nop 1
  v_add_f32_dpp v14, v14, v14 row_ror:8 row_mask:0xf bank_mask:0xf
  s_cmp_lg_u32 s90, 0
  s_cbranch_vccnz L_pta5
  s_cbranch_scc1 L_ptb5
  s_waitcnt vmcnt(3)
L_ptb5:
  s_waitcnt vmcnt(4)
L_pta5:
  s_cbranch_scc1 L_ptc5
  s_waitcnt vmcnt(5)
L_ptc5:
  s_waitcnt vmcnt(9)
  buffer_load_dwordx4 v[132:135], v3, s[16:19], s37 offen offset:1024 nt
  s_nop 1
  v_add_f32_dpp v14, v14, v14 row_ror:4 row_mask:0xf bank_mask:0xf
  s_nop 1
  v_add_f32_dpp v14, v14, v14 row_ror:2 row_mask:0xf bank_mask:0xf
  s_nop 1
  v_add_f32_dpp v14, v14, v14 row_ror:1 row_mask:0xf bank_mask:0xf
  v_mov_b32 v176, v14
  s_nop 1
  v_permlane16_swap_b32 v176, v14
  s_nop 1
  v_add_f32 v14, v14, v176
  v_mov_b32 v176, v14
  s_nop 1
  v_permlane32_swap_b32 v176, v14
  s_nop 1
  v_add_f32 v14, v14, v176
  s_lshl_b32 s3, s28, 3
  v_add_u32 v178, s3, v188
  ds_write_b32 v178, v15 offset:6144
  ds_write_b32 v178, v14 offset:6148
  v_mov_b32 v179, 1
  s_waitcnt lgkmcnt(0)
  s_mov_b64 exec, 1
  ds_add_u32 v188, v179 offset:6224
  s_mov_b64 exec, -1
  s_cmp_lg_u32 s90, 0
  s_cbranch_vccnz L_pta6
  s_cbranch_scc1 L_ptb6
  s_waitcnt vmcnt(3)
L_ptb6:
  s_waitcnt vmcnt(4)
L_pta6:
  s_cbranch_scc1 L_ptc6
  s_waitcnt vmcnt(5)
L_ptc6:
  s_waitcnt vmcnt(9)
  buffer_load_dwordx4 v[136:139], v3, s[16:19], s37 offen offset:2048 nt
  s_memrealtime s[98:99]
  s_lshr_b32 s93, s92, 3
  s_add_u32 s49, s49, s93
  s_cmp_lg_u32 s90, 0
  s_cbranch_vccnz L_pta7
  s_cbranch_scc1 L_ptb7
  s_waitcnt vmcnt(3)
L_ptb7:
  s_waitcnt vmcnt(4)
L_pta7:
  s_cbranch_scc1 L_ptc7
  s_waitcnt vmcnt(5)
L_ptc7:
  s_waitcnt vmcnt(9)
  buffer_load_dwordx4 v[140:143], v3, s[16:19], s37 offen offset:3072 nt
  s_waitcnt lgkmcnt(0)
  s_sub_u32 s79, s98, s49
  s_add_u32 s93, s79, 1500
  s_cmp_lt_u32 s93, 3000
  s_cselect_b32 s79, s79, -15
  s_cmp_ge_i32 s79, 25
  s_cselect_b64 vcc, -1, 0
  s_cselect_b32 s93, s5, s4
  s_cmp_ge_i32 s79, s93
  s_cselect_b32 s90, 1, 0
  s_cmp_lg_u32 s90, 0
  s_cbranch_vccnz L_pta8
  s_cbranch_scc1 L_ptb8
  s_waitcnt vmcnt(3)
L_ptb8:
  s_waitcnt vmcnt(4)
L_pta8:
  s_cbranch_scc1 L_ptc8
  s_waitcnt vmcnt(5)
L_ptc8:
  s_waitcnt vmcnt(9)
  buffer_load_dwordx4 v[144:147], v3, s[16:19], s38 offen offset:0 nt
  s_add_u32 s91, s50, 64
  s_sub_u32 s80, s91, s80
  s_cmp_lt_u32 s80, 2500
  s_cselect_b32 s80, s80, 0
  s_sub_u32 s81, s91, s81
  s_cmp_lt_u32 s81, 2500
  s_cselect_b32 s81, s81, 0
  s_add_u32 s80, s80, s81
  s_cmp_lg_u32 s90, 0
  s_cbranch_vccnz L_pta9
  s_cbranch_scc1 L_ptb9
  s_waitcnt vmcnt(3)
L_ptb9:
  s_waitcnt vmcnt(4)
L_pta9:
  s_cbranch_scc1 L_ptc9
  s_waitcnt vmcnt(5)
L_ptc9:
  s_waitcnt vmcnt(9)
  buffer_load_dwordx4 v[148:151], v3, s[16:19], s38 offen offset:1024 nt
  s_sub_u32 s82, s91, s82
  s_cmp_lt_u32 s82, 2500
  s_cselect_b32 s82, s82, 0
  s_add_u32 s80, s80, s82
  s_sub_u32 s83, s91, s83
  s_cmp_lt_u32 s83, 2500
  s_cselect_b32 s83, s83, 0
  s_add_u32 s80, s80, s83
  s_cmp_lg_u32 s90, 0
  s_cbranch_vccnz L_pta10
  s_cbranch_scc1 L_ptb10
  s_waitcnt vmcnt(3)
L_ptb10:
  s_waitcnt vmcnt(4)
L_pta10:
  s_cbranch_scc1 L_ptc10
  s_waitcnt vmcnt(5)
L_ptc10:
  s_waitcnt vmcnt(9)
  buffer_load_dwordx4 v[152:155], v3, s[16:19], s38 offen offset:2048 nt
  s_sub_u32 s84, s91, s84
  s_cmp_lt_u32 s84, 2500
  s_cselect_b32 s84, s84, 0
  s_add_u32 s80, s80, s84
  s_sub_u32 s85, s91, s85
  s_cmp_lt_u32 s85, 2500
  s_cselect_b32 s85, s85, 0
  s_add_u32 s80, s80, s85
  s_cmp_lg_u32 s90, 0
  s_cbranch_vccnz L_pta11
  s_cbranch_scc1 L_ptb11
  s_waitcnt vmcnt(3)
L_ptb11:
  s_waitcnt vmcnt(4)
L_pta11:
  s_cbranch_scc1 L_ptc11
  s_waitcnt vmcnt(5)
L_ptc11:
  s_waitcnt vmcnt(9)
  buffer_load_dwordx4 v[156:159], v3, s[16:19], s38 offen offset:3072 nt
  s_sub_u32 s86, s91, s86
  s_cmp_lt_u32 s86, 2500
  s_cselect_b32 s86, s86, 0
  s_add_u32 s80, s80, s86
  s_sub_u32 s87, s91, s87
  s_cmp_lt_u32 s87, 2500
  s_cselect_b32 s87, s87, 0
  s_add_u32 s80, s80, s87
  s_lshr_b32 s55, s80, 3
  s_sub_u32 s55, s91, s55
L_smwait:
  ds_read_b32 v176, v188 offset:6224
  s_waitcnt lgkmcnt(0)
  v_readfirstlane_b32 s3, v176
  s_cmp_ge_u32 s3, 4
  s_cbranch_scc1 L_smwait_ok
  s_sub_u32 s69, s69, 1
  s_cbranch_scc0 L_smwait
  s_mov_b32 s69, 0
L_smwait_ok:
  s_cmp_lg_u32 s90, 0
  s_cbranch_vccnz L_pta12
  s_cbranch_scc1 L_ptb12
  s_waitcnt vmcnt(3)
L_ptb12:
  s_waitcnt vmcnt(4)
L_pta12:
  s_cbranch_scc1 L_ptc12
  s_waitcnt vmcnt(5)
L_ptc12:
  s_waitcnt vmcnt(9)
  buffer_load_dwordx4 v[160:163], v3, s[16:19], s39 offen offset:0 nt
  s_sub_u32 s91, s55, s57
  s_add_u32 s49, s92, 3
  s_min_u32 s91, s91, s49
  s_sub_u32 s49, s92, 3
  s_max_u32 s91, s91, s49
  s_cmp_ge_u32 s48, 1280
  s_cselect_b32 s92, s91, s92
  s_mul_i32 s91, s92, 2
  ds_read_b128 v[176:179], v188 offset:6144
  ds_read_b128 v[180:183], v188 offset:6160
  s_waitcnt lgkmcnt(0)
  v_max3_f32 v184, v176, v178, v180
  v_max_f32 v184, v184, v182
  v_sub_f32 v176, v176, v184
  v_sub_f32 v178, v178, v184
  v_sub_f32 v180, v180, v184
  v_sub_f32 v182, v182, v184
  v_sub_f32 v185, v15, v184
  v_mul_f32 v176, 0x3fb8aa3b, v176
  v_mul_f32 v178, 0x3fb8aa3b, v178
  v_mul_f32 v180, 0x3fb8aa3b, v180
  v_mul_f32 v182, 0x3fb8aa3b, v182
  s_cmp_lg_u32 s90, 0
  s_cbranch_vccnz L_pta13
  s_cbranch_scc1 L_ptb13
  s_waitcnt vmcnt(3)
L_ptb13:
  s_waitcnt vmcnt(4)
L_pta13:
  s_cbranch_scc1 L_ptc13
  s_waitcnt vmcnt(5)
L_ptc13:
  s_waitcnt vmcnt(9)
  buffer_load_dwordx4 v[164:167], v3, s[16:19], s39 offen offset:1024 nt
  s_lshr_b32 s91, s91, 2
  s_add_u32 s49, s55, s91
  s_mov_b32 s57, s56
  s_mov_b32 s56, s53
  s_mov_b32 s53, s52
  s_mov_b32 s52, s55
  v_mul_f32 v185, 0x3fb8aa3b, v185
  v_exp_f32 v176, v176
  v_exp_f32 v178, v178
  v_exp_f32 v180, v180
  v_exp_f32 v182, v182
  v_exp_f32 v185, v185
  v_mul_f32 v184, v176, v177
  v_fmac_f32 v184, v178, v179
  v_fmac_f32 v184, v180, v181
  v_fmac_f32 v184, v182, v183
  v_rcp_f32 v184, v184
  s_nop 0
  v_mul_f32 v14, v185, v184
  v_mul_f32 v16, v16, v14
  s_cmp_lg_u32 s90, 0
  s_cbranch_vccnz L_pta14
  s_cbranch_scc1 L_ptb14
  s_waitcnt vmcnt(3)
L_ptb14:
  s_waitcnt vmcnt(4)
L_pta14:
  s_cbranch_scc1 L_ptc14
  s_waitcnt vmcnt(5)
L_ptc14:
  s_waitcnt vmcnt(9)
  buffer_load_dwordx4 v[168:171], v3, s[16:19], s39 offen offset:2048 nt
  s_add_u32 s91, s50, 0x40000000
  s_cmp_lt_u32 s48, 128
  s_cselect_b32 s49, s91, s49
  s_add_u32 s48, s48, 128
  s_memrealtime s[50:51]
  v_mul_f32 v17, v17, v14
  v_mul_f32 v18, v18, v14
  v_mul_f32 v19, v19, v14
  v_mul_f32 v20, v20, v14
  v_mul_f32 v21, v21, v14
  v_mul_f32 v22, v22, v14
  v_mul_f32 v23, v23, v14
  v_mul_f32 v24, v24, v14
  v_mul_f32 v25, v25, v14
  v_mul_f32 v26, v26, v14
  v_mul_f32 v27, v27, v14
  v_mul_f32 v28, v28, v14
  v_mul_f32 v29, v29, v14
  v_cvt_pk_bf16_f32 v16, v16, v16
  s_cmp_lg_u32 s90, 0
  s_cbranch_vccnz L_pta15
  s_cbranch_scc1 L_ptb15
  s_waitcnt vmcnt(3)
L_ptb15:
  s_waitcnt vmcnt(4)
L_pta15:
  s_cbranch_scc1 L_ptc15
  s_waitcnt vmcnt(5)
L_ptc15:
  s_waitcnt vmcnt(9)
  buffer_load_dwordx4 v[172:175], v3, s[16:19], s39 offen offset:3072 nt
  v_cvt_pk_bf16_f32 v17, v17, v17
  v_cvt_pk_bf16_f32 v18, v18, v18
  v_cvt_pk_bf16_f32 v19, v19, v19
  v_cvt_pk_bf16_f32 v20, v20, v20
  v_cvt_pk_bf16_f32 v21, v21, v21
  v_cvt_pk_bf16_f32 v22, v22, v22
  v_cvt_pk_bf16_f32 v23, v23, v23
  v_cvt_pk_bf16_f32 v24, v24, v24
  v_cvt_pk_bf16_f32 v25, v25, v25
  v_cvt_pk_bf16_f32 v26, v26, v26
  v_cvt_pk_bf16_f32 v27, v27, v27
  v_cvt_pk_bf16_f32 v28, v28, v28
  v_cvt_pk_bf16_f32 v29, v29, v29
  s_add_u32 s29, s29, 1
  s_bfe_u32 s35, s29, 65536
  s_lshl_b32 s35, s35, 15
  s_bfe_u32 s3, s29, 131073
  s_lshl_b32 s3, s3, 17
  s_or_b32 s35, s35, s3
  s_bfe_u32 s3, s29, 65539
  s_lshl_b32 s3, s3, 12
  s_or_b32 s35, s35, s3
  v_xor_b32 v3, s35, v189
  s_waitcnt lgkmcnt(0)
  s_sub_u32 s79, s50, s49
  s_add_u32 s93, s79, 1500
  s_cmp_lt_u32 s93, 3000
  s_cselect_b32 s79, s79, -15
  s_cmp_ge_i32 s79, 25
  s_cselect_b64 vcc, -1, 0
  s_cselect_b32 s93, s5, s4
  s_cmp_ge_i32 s79, s93
  s_cselect_b32 s90, 1, 0
  v_and_b32_dpp v36, v16, v32 row_newbcast:0 row_mask:0xf bank_mask:0xf
  v_and_b32_dpp v37, v16, v33 row_newbcast:0 row_mask:0xf bank_mask:0xf
  v_and_b32_dpp v38, v16, v34 row_newbcast:0 row_mask:0xf bank_mask:0xf
  v_and_b32_dpp v39, v16, v35 row_newbcast:0 row_mask:0xf bank_mask:0xf
  v_and_b32_dpp v40, v17, v32 row_newbcast:0 row_mask:0xf bank_mask:0xf
  v_and_b32_dpp v41, v17, v33 row_newbcast:0 row_mask:0xf bank_mask:0xf
  v_and_b32_dpp v42, v17, v34 row_newbcast:0 row_mask:0xf bank_mask:0xf
  v_and_b32_dpp v43, v17, v35 row_newbcast:0 row_mask:0xf bank_mask:0xf
  v_mfma_f32_16x16x32_bf16 v[44:47], v[36:39], v[48:51], v[44:47]
  s_cbranch_vccnz L_pxa0
  s_cbranch_scc1 L_pxb0
  s_waitcnt vmcnt(3)
L_pxb0:
  s_waitcnt vmcnt(4)
L_pxa0:
  s_cbranch_scc1 L_pxc0
  s_waitcnt vmcnt(5)
L_pxc0:
  s_waitcnt vmcnt(9)
  buffer_load_dwordx4 v[48:51], v3, s[16:19], 0 offen offset:0 nt
  v_and_b32_dpp v36, v29, v32 row_newbcast:0 row_mask:0xf bank_mask:0xf
  v_and_b32_dpp v37, v29, v33 row_newbcast:0 row_mask:0xf bank_mask:0xf
  v_and_b32_dpp v38, v29, v34 row_newbcast:0 row_mask:0xf bank_mask:0xf
  v_and_b32_dpp v39, v29, v35 row_newbcast:0 row_mask:0xf bank_mask:0xf
  v_mfma_f32_16x16x32_bf16 v[44:47], v[40:43], v[112:115], v[44:47]
  s_nop 0
  v_mfma_f32_16x16x32_bf16 v[44:47], v[36:39], v[190:193], v[44:47]
  v_and_b32_dpp v36, v16, v32 row_newbcast:8 row_mask:0xf bank_mask:0xf
  v_and_b32_dpp v37, v16, v33 row_newbcast:8 row_mask:0xf bank_mask:0xf
  v_and_b32_dpp v38, v16, v34 row_newbcast:8 row_mask:0xf bank_mask:0xf
  v_and_b32_dpp v39, v16, v35 row_newbcast:8 row_mask:0xf bank_mask:0xf
  s_and_b32 s93, s48, 384
  s_cmp_lg_u32 s54, s93
  s_cbranch_scc1 L_ck6_nopub
  v_mov_b32 v187, s50
  s_mov_b64 exec, 1
  buffer_store_dword v187, off, s[20:23], s48 sc1
  s_mov_b64 exec, -1
L_ck6_nopub:
  s_cmp_lg_u32 s90, 0
  v_and_b32_dpp v40, v17, v32 row_newbcast:8 row_mask:0xf bank_mask:0xf
  v_and_b32_dpp v41, v17, v33 row_newbcast:8 row_mask:0xf bank_mask:0xf
  v_and_b32_dpp v42, v17, v34 row_newbcast:8 row_mask:0xf bank_mask:0xf
  v_and_b32_dpp v43, v17, v35 row_newbcast:8 row_mask:0xf bank_mask:0xf
  v_mfma_f32_16x16x32_bf16 v[44:47], v[36:39], v[52:55], v[44:47]
  s_cbranch_vccnz L_pxa1
  s_cbranch_scc1 L_pxb1
  s_waitcnt vmcnt(3)
L_pxb1:
  s_waitcnt vmcnt(4)
L_pxa1:
  s_cbranch_scc1 L_pxc1
  s_waitcnt vmcnt(5)
L_pxc1:
  s_waitcnt vmcnt(9)
  buffer_load_dwordx4 v[52:55], v3, s[16:19], 0 offen offset:1024 nt
  v_and_b32_dpp v36, v29, v32 row_newbcast:8 row_mask:0xf bank_mask:0xf
  v_and_b32_dpp v37, v29, v33 row_newbcast:8 row_mask:0xf bank_mask:0xf
  v_and_b32_dpp v38, v29, v34 row_newbcast:8 row_mask:0xf bank_mask:0xf
  v_and_b32_dpp v39, v29, v35 row_newbcast:8 row_mask:0xf bank_mask:0xf
  v_mfma_f32_16x16x32_bf16 v[44:47], v[40:43], v[116:119], v[44:47]
  s_nop 0
  v_mfma_f32_16x16x32_bf16 v[44:47], v[36:39], v[194:197], v[44:47]
  v_and_b32_dpp v36, v16, v32 row_newbcast:4 row_mask:0xf bank_mask:0xf
  v_and_b32_dpp v37, v16, v33 row_newbcast:4 row_mask:0xf bank_mask:0xf
  v_and_b32_dpp v38, v16, v34 row_newbcast:4 row_mask:0xf bank_mask:0xf
  v_and_b32_dpp v39, v16, v35 row_newbcast:4 row_mask:0xf bank_mask:0xf
  s_add_u32 s88, s46, s48
  s_addc_u32 s89, s47, 0
  s_cmp_lt_u32 s48, 128
  s_cbranch_scc1 L_ck6_early
  s_load_dword s80, s[88:89], 0
  s_load_dword s81, s[88:89], 5120
  s_load_dword s82, s[88:89], 10240
  s_load_dword s83, s[88:89], 15360
  s_load_dword s84, s[88:89], 20480
  s_load_dword s85, s[88:89], 25600
  s_load_dword s86, s[88:89], 30720
  s_load_dword s87, s[88:89], 35840
L_ck6_early:
  s_cmp_lg_u32 s90, 0
  v_and_b32_dpp v40, v17, v32 row_newbcast:4 row_mask:0xf bank_mask:0xf
  v_and_b32_dpp v41, v17, v33 row_newbcast:4 row_mask:0xf bank_mask:0xf
  v_and_b32_dpp v42, v17, v34 row_newbcast:4 row_mask:0xf bank_mask:0xf
  v_and_b32_dpp v43, v17, v35 row_newbcast:4 row_mask:0xf bank_mask:0xf
  v_mfma_f32_16x16x32_bf16 v[44:47], v[36:39], v[56:59], v[44:47]
  s_cbranch_vccnz L_pxa2
  s_cbranch_scc1 L_pxb2
  s_waitcnt vmcnt(3)
L_pxb2:
  s_waitcnt vmcnt(4)
L_pxa2:
  s_cbranch_scc1 L_pxc2
  s_waitcnt vmcnt(5)
L_pxc2:
  s_waitcnt vmcnt(9)
  buffer_load_dwordx4 v[56:59], v3, s[16:19], 0 offen offset:2048 nt
  v_and_b32_dpp v36, v29, v32 row_newbcast:4 row_mask:0xf bank_mask:0xf
  v_and_b32_dpp v37, v29, v33 row_newbcast:4 row_mask:0xf bank_mask:0xf
  v_and_b32_dpp v38, v29, v34 row_newbcast:4 row_mask:0xf bank_mask:0xf
  v_and_b32_dpp v39, v29, v35 row_newbcast:4 row_mask:0xf bank_mask:0xf
  v_mfma_f32_16x16x32_bf16 v[44:47], v[40:43], v[120:123], v[44:47]
  s_nop 0
  v_mfma_f32_16x16x32_bf16 v[44:47], v[36:39], v[198:201], v[44:47]
  v_and_b32_dpp v36, v16, v32 row_newbcast:12 row_mask:0xf bank_mask:0xf
  v_and_b32_dpp v37, v16, v33 row_newbcast:12 row_mask:0xf bank_mask:0xf
  v_and_b32_dpp v38, v16, v34 row_newbcast:12 row_mask:0xf bank_mask:0xf
  v_and_b32_dpp v39, v16, v35 row_newbcast:12 row_mask:0xf bank_mask:0xf
  v_and_b32_dpp v40, v17, v32 row_newbcast:12 row_mask:0xf bank_mask:0xf
  v_and_b32_dpp v41, v17, v33 row_newbcast:12 row_mask:0xf bank_mask:0xf
  v_and_b32_dpp v42, v17, v34 row_newbcast:12 row_mask:0xf bank_mask:0xf
  v_and_b32_dpp v43, v17, v35 row_newbcast:12 row_mask:0xf bank_mask:0xf
  v_mfma_f32_16x16x32_bf16 v[44:47], v[36:39], v[60:63], v[44:47]
  s_cbranch_vccnz L_pxa3
  s_cbranch_scc1 L_pxb3
  s_waitcnt vmcnt(3)
L_pxb3:
  s_waitcnt vmcnt(4)
L_pxa3:
  s_cbranch_scc1 L_pxc3
  s_waitcnt vmcnt(5)
L_pxc3:
  s_waitcnt vmcnt(9)
  buffer_load_dwordx4 v[60:63], v3, s[16:19], 0 offen offset:3072 nt
  v_and_b32_dpp v36, v29, v32 row_newbcast:12 row_mask:0xf bank_mask:0xf
  v_and_b32_dpp v37, v29, v33 row_newbcast:12 row_mask:0xf bank_mask:0xf
  v_and_b32_dpp v38, v29, v34 row_newbcast:12 row_mask:0xf bank_mask:0xf
  v_and_b32_dpp v39, v29, v35 row_newbcast:12 row_mask:0xf bank_mask:0xf
  v_mfma_f32_16x16x32_bf16 v[44:47], v[40:43], v[124:127], v[44:47]
  s_nop 0
  v_mfma_f32_16x16x32_bf16 v[44:47], v[36:39], v[202:205], v[44:47]
  v_and_b32_dpp v36, v16, v32 row_newbcast:1 row_mask:0xf bank_mask:0xf
  v_and_b32_dpp v37, v16, v33 row_newbcast:1 row_mask:0xf bank_mask:0xf
  v_and_b32_dpp v38, v16, v34 row_newbcast:1 row_mask:0xf bank_mask:0xf
  v_and_b32_dpp v39, v16, v35 row_newbcast:1 row_mask:0xf bank_mask:0xf
  v_and_b32_dpp v40, v17, v32 row_newbcast:1 row_mask:0xf bank_mask:0xf
  v_and_b32_dpp v41, v17, v33 row_newbcast:1 row_mask:0xf bank_mask:0xf
  v_and_b32_dpp v42, v17, v34 row_newbcast:1 row_mask:0xf bank_mask:0xf
  v_and_b32_dpp v43, v17, v35 row_newbcast:1 row_mask:0xf bank_mask:0xf
  v_mfma_f32_16x16x32_bf16 v[44:47], v[36:39], v[64:67], v[44:47]
  s_cbranch_vccnz L_pxa4
  s_cbranch_scc1 L_pxb4
  s_waitcnt vmcnt(3)
L_pxb4:
  s_waitcnt vmcnt(4)
L_pxa4:
  s_cbranch_scc1 L_pxc4
  s_waitcnt vmcnt(5)
L_pxc4:
  s_waitcnt vmcnt(9)
  buffer_load_dwordx4 v[64:67], v3, s[16:19], s37 offen offset:0 nt
  v_and_b32_dpp v36, v29, v32 row_newbcast:1 row_mask:0xf bank_mask:0xf
  v_and_b32_dpp v37, v29, v33 row_newbcast:1 row_mask:0xf bank_mask:0xf
  v_and_b32_dpp v38, v29, v34 row_newbcast:1 row_mask:0xf bank_mask:0xf
  v_and_b32_dpp v39, v29, v35 row_newbcast:1 row_mask:0xf bank_mask:0xf
  v_mfma_f32_16x16x32_bf16 v[44:47], v[40:43], v[128:131], v[44:47]
  s_nop 0
  v_mfma_f32_16x16x32_bf16 v[44:47], v[36:39], v[206:209], v[44:47]
  v_and_b32_dpp v36, v16, v32 row_newbcast:9 row_mask:0xf bank_mask:0xf
  v_and_b32_dpp v37, v16, v33 row_newbcast:9 row_mask:0xf bank_mask:0xf
  v_and_b32_dpp v38, v16, v34 row_newbcast:9 row_mask:0xf bank_mask:0xf
  v_and_b32_dpp v39, v16, v35 row_newbcast:9 row_mask:0xf bank_mask:0xf
  v_and_b32_dpp v40, v17, v32 row_newbcast:9 row_mask:0xf bank_mask:0xf
  v_and_b32_dpp v41, v17, v33 row_newbcast:9 row_mask:0xf bank_mask:0xf
  v_and_b32_dpp v42, v17, v34 row_newbcast:9 row_mask:0xf bank_mask:0xf
  v_and_b32_dpp v43, v17, v35 row_newbcast:9 row_mask:0xf bank_mask:0xf
  v_mfma_f32_16x16x32_bf16 v[44:47], v[36:39], v[68:71], v[44:47]
  s_cbranch_vccnz L_pxa5
  s_cbranch_scc1 L_pxb5
  s_waitcnt vmcnt(3)
L_pxb5:
  s_waitcnt vmcnt(4)
L_pxa5:
  s_cbranch_scc1 L_pxc5
  s_waitcnt vmcnt(5)
L_pxc5:
  s_waitcnt vmcnt(9)
  buffer_load_dwordx4 v[68:71], v3, s[16:19], s37 offen offset:1024 nt
  v_and_b32_dpp v36, v29, v32 row_newbcast:9 row_mask:0xf bank_mask:0xf
  v_and_b32_dpp v37, v29, v33 row_newbcast:9 row_mask:0xf bank_mask:0xf
  v_and_b32_dpp v38, v29, v34 row_newbcast:9 row_mask:0xf bank_mask:0xf
  v_and_b32_dpp v39, v29, v35 row_newbcast:9 row_mask:0xf bank_mask:0xf
  v_mfma_f32_16x16x32_bf16 v[44:47], v[40:43], v[132:135], v[44:47]
  s_nop 0
  v_mfma_f32_16x16x32_bf16 v[44:47], v[36:39], v[210:213], v[44:47]
  v_and_b32_dpp v36, v16, v32 row_newbcast:5 row_mask:0xf bank_mask:0xf
  v_and_b32_dpp v37, v16, v33 row_newbcast:5 row_mask:0xf bank_mask:0xf
  v_and_b32_dpp v38, v16, v34 row_newbcast:5 row_mask:0xf bank_mask:0xf
  v_and_b32_dpp v39, v16, v35 row_newbcast:5 row_mask:0xf bank_mask:0xf
  v_and_b32_dpp v40, v17, v32 row_newbcast:5 row_mask:0xf bank_mask:0xf
  v_and_b32_dpp v41, v17, v33 row_newbcast:5 row_mask:0xf bank_mask:0xf
  v_and_b32_dpp v42, v17, v34 row_newbcast:5 row_mask:0xf bank_mask:0xf
  v_and_b32_dpp v43, v17, v35 row_newbcast:5 row_mask:0xf bank_mask:0xf
  v_mfma_f32_16x16x32_bf16 v[44:47], v[36:39], v[72:75], v[44:47]
  s_cbranch_vccnz L_pxa6
  s_cbranch_scc1 L_pxb6
  s_waitcnt vmcnt(3)
L_pxb6:
  s_waitcnt vmcnt(4)
L_pxa6:
  s_cbranch_scc1 L_pxc6
  s_waitcnt vmcnt(5)
L_pxc6:
  s_waitcnt vmcnt(9)
  buffer_load_dwordx4 v[72:75], v3, s[16:19], s37 offen offset:2048 nt
  v_and_b32_dpp v36, v29, v32 row_newbcast:5 row_mask:0xf bank_mask:0xf
  v_and_b32_dpp v37, v29, v33 row_newbcast:5 row_mask:0xf bank_mask:0xf
  v_and_b32_dpp v38, v29, v34 row_newbcast:5 row_mask:0xf bank_mask:0xf
  v_and_b32_dpp v39, v29, v35 row_newbcast:5 row_mask:0xf bank_mask:0xf
  v_mfma_f32_16x16x32_bf16 v[44:47], v[40:43], v[136:139], v[44:47]
  s_nop 0
  v_mfma_f32_16x16x32_bf16 v[44:47], v[36:39], v[214:217], v[44:47]
  v_and_b32_dpp v36, v16, v32 row_newbcast:13 row_mask:0xf bank_mask:0xf
  v_and_b32_dpp v37, v16, v33 row_newbcast:13 row_mask:0xf bank_mask:0xf
  v_and_b32_dpp v38, v16, v34 row_newbcast:13 row_mask:0xf bank_mask:0xf
  v_and_b32_dpp v39, v16, v35 row_newbcast:13 row_mask:0xf bank_mask:0xf
  s_memrealtime s[98:99]
  s_lshr_b32 s93, s92, 3
  s_add_u32 s49, s49, s93
  s_cmp_lg_u32 s90, 0
  v_and_b32_dpp v40, v17, v32 row_newbcast:13 row_mask:0xf bank_mask:0xf
  v_and_b32_dpp v41, v17, v33 row_newbcast:13 row_mask:0xf bank_mask:0xf
  v_and_b32_dpp v42, v17, v34 row_newbcast:13 row_mask:0xf bank_mask:0xf
  v_and_b32_dpp v43, v17, v35 row_newbcast:13 row_mask:0xf bank_mask:0xf
  v_mfma_f32_16x16x32_bf16 v[44:47], v[36:39], v[76:79], v[44:47]
  s_cbranch_vccnz L_pxa7
  s_cbranch_scc1 L_pxb7
  s_waitcnt vmcnt(3)
L_pxb7:
  s_waitcnt vmcnt(4)
L_pxa7:
  s_cbranch_scc1 L_pxc7
  s_waitcnt vmcnt(5)
L_pxc7:
  s_waitcnt vmcnt(9)
  buffer_load_dwordx4 v[76:79], v3, s[16:19], s37 offen offset:3072 nt
  v_and_b32_dpp v36, v29, v32 row_newbcast:13 row_mask:0xf bank_mask:0xf
  v_and_b32_dpp v37, v29, v33 row_newbcast:13 row_mask:0xf bank_mask:0xf
  v_and_b32_dpp v38, v29, v34 row_newbcast:13 row_mask:0xf bank_mask:0xf
  v_and_b32_dpp v39, v29, v35 row_newbcast:13 row_mask:0xf bank_mask:0xf
  v_mfma_f32_16x16x32_bf16 v[44:47], v[40:43], v[140:143], v[44:47]
  s_nop 0
  v_mfma_f32_16x16x32_bf16 v[44:47], v[36:39], v[218:221], v[44:47]
  v_and_b32_dpp v36, v16, v32 row_newbcast:2 row_mask:0xf bank_mask:0xf
  v_and_b32_dpp v37, v16, v33 row_newbcast:2 row_mask:0xf bank_mask:0xf
  v_and_b32_dpp v38, v16, v34 row_newbcast:2 row_mask:0xf bank_mask:0xf
  v_and_b32_dpp v39, v16, v35 row_newbcast:2 row_mask:0xf bank_mask:0xf
  s_waitcnt lgkmcnt(0)
  s_sub_u32 s79, s98, s49
  s_add_u32 s93, s79, 1500
  s_cmp_lt_u32 s93, 3000
  s_cselect_b32 s79, s79, -15
  s_cmp_ge_i32 s79, 25
  s_cselect_b64 vcc, -1, 0
  s_cselect_b32 s93, s5, s4
  s_cmp_ge_i32 s79, s93
  s_cselect_b32 s90, 1, 0
  s_cmp_lg_u32 s90, 0
  v_and_b32_dpp v40, v17, v32 row_newbcast:2 row_mask:0xf bank_mask:0xf
  v_and_b32_dpp v41, v17, v33 row_newbcast:2 row_mask:0xf bank_mask:0xf
  v_and_b32_dpp v42, v17, v34 row_newbcast:2 row_mask:0xf bank_mask:0xf
  v_and_b32_dpp v43, v17, v35 row_newbcast:2 row_mask:0xf bank_mask:0xf
  v_mfma_f32_16x16x32_bf16 v[44:47], v[36:39], v[80:83], v[44:47]
  s_cbranch_vccnz L_pxa8
  s_cbranch_scc1 L_pxb8
  s_waitcnt vmcnt(3)
L_pxb8:
  s_waitcnt vmcnt(4)
L_pxa8:
  s_cbranch_scc1 L_pxc8
  s_waitcnt vmcnt(5)
L_pxc8:
  s_waitcnt vmcnt(9)
  buffer_load_dwordx4 v[80:83], v3, s[16:19], s38 offen offset:0 nt
  v_and_b32_dpp v36, v29, v32 row_newbcast:2 row_mask:0xf bank_mask:0xf
  v_and_b32_dpp v37, v29, v33 row_newbcast:2 row_mask:0xf bank_mask:0xf
  v_and_b32_dpp v38, v29, v34 row_newbcast:2 row_mask:0xf bank_mask:0xf
  v_and_b32_dpp v39, v29, v35 row_newbcast:2 row_mask:0xf bank_mask:0xf
  v_mfma_f32_16x16x32_bf16 v[44:47], v[40:43], v[144:147], v[44:47]
  s_nop 0
  v_mfma_f32_16x16x32_bf16 v[44:47], v[36:39], v[222:225], v[44:47]
  v_and_b32_dpp v36, v16, v32 row_newbcast:10 row_mask:0xf bank_mask:0xf
  v_and_b32_dpp v37, v16, v33 row_newbcast:10 row_mask:0xf bank_mask:0xf
  v_and_b32_dpp v38, v16, v34 row_newbcast:10 row_mask:0xf bank_mask:0xf
  v_and_b32_dpp v39, v16, v35 row_newbcast:10 row_mask:0xf bank_mask:0xf
  s_add_u32 s91, s50, 64
  s_sub_u32 s80, s91, s80
  s_cmp_lt_u32 s80, 2500
  s_cselect_b32 s80, s80, 0
  s_sub_u32 s81, s91, s81
  s_cmp_lt_u32 s81, 2500
  s_cselect_b32 s81, s81, 0
  s_add_u32 s80, s80, s81
  s_cmp_lg_u32 s90, 0
  v_and_b32_dpp v40, v17, v32 row_newbcast:10 row_mask:0xf bank_mask:0xf
  v_and_b32_dpp v41, v17, v33 row_newbcast:10 row_mask:0xf bank_mask:0xf
  v_and_b32_dpp v42, v17, v34 row_newbcast:10 row_mask:0xf bank_mask:0xf
  v_and_b32_dpp v43, v17, v35 row_newbcast:10 row_mask:0xf bank_mask:0xf
  v_mfma_f32_16x16x32_bf16 v[44:47], v[36:39], v[84:87], v[44:47]
  s_cbranch_vccnz L_pxa9
  s_cbranch_scc1 L_pxb9
  s_waitcnt vmcnt(3)
L_pxb9:
  s_waitcnt vmcnt(4)
L_pxa9:
  s_cbranch_scc1 L_pxc9
  s_waitcnt vmcnt(5)
L_pxc9:
  s_waitcnt vmcnt(9)
  buffer_load_dwordx4 v[84:87], v3, s[16:19], s38 offen offset:1024 nt
  v_and_b32_dpp v36, v29, v32 row_newbcast:10 row_mask:0xf bank_mask:0xf
  v_and_b32_dpp v37, v29, v33 row_newbcast:10 row_mask:0xf bank_mask:0xf
  v_and_b32_dpp v38, v29, v34 row_newbcast:10 row_mask:0xf bank_mask:0xf
  v_and_b32_dpp v39, v29, v35 row_newbcast:10 row_mask:0xf bank_mask:0xf
  v_mfma_f32_16x16x32_bf16 v[44:47], v[40:43], v[148:151], v[44:47]
  s_nop 0
  v_mfma_f32_16x16x32_bf16 v[44:47], v[36:39], v[226:229], v[44:47]
  v_and_b32_dpp v36, v16, v32 row_newbcast:6 row_mask:0xf bank_mask:0xf
  v_and_b32_dpp v37, v16, v33 row_newbcast:6 row_mask:0xf bank_mask:0xf
  v_and_b32_dpp v38, v16, v34 row_newbcast:6 row_mask:0xf bank_mask:0xf
  v_and_b32_dpp v39, v16, v35 row_newbcast:6 row_mask:0xf bank_mask:0xf
  s_sub_u32 s82, s91, s82
  s_cmp_lt_u32 s82, 2500
  s_cselect_b32 s82, s82, 0
  s_add_u32 s80, s80, s82
  s_sub_u32 s83, s91, s83
  s_cmp_lt_u32 s83, 2500
  s_cselect_b32 s83, s83, 0
  s_add_u32 s80, s80, s83
  s_cmp_lg_u32 s90, 0
  v_and_b32_dpp v40, v17, v32 row_newbcast:6 row_mask:0xf bank_mask:0xf
  v_and_b32_dpp v41, v17, v33 row_newbcast:6 row_mask:0xf bank_mask:0xf
  v_and_b32_dpp v42, v17, v34 row_newbcast:6 row_mask:0xf bank_mask:0xf
  v_and_b32_dpp v43, v17, v35 row_newbcast:6 row_mask:0xf bank_mask:0xf
  v_mfma_f32_16x16x32_bf16 v[44:47], v[36:39], v[88:91], v[44:47]
  s_cbranch_vccnz L_pxa10
  s_cbranch_scc1 L_pxb10
  s_waitcnt vmcnt(3)
L_pxb10:
  s_waitcnt vmcnt(4)
L_pxa10:
  s_cbranch_scc1 L_pxc10
  s_waitcnt vmcnt(5)
L_pxc10:
  s_waitcnt vmcnt(9)
  buffer_load_dwordx4 v[88:91], v3, s[16:19], s38 offen offset:2048 nt
  v_and_b32_dpp v36, v29, v32 row_newbcast:6 row_mask:0xf bank_mask:0xf
  v_and_b32_dpp v37, v29, v33 row_newbcast:6 row_mask:0xf bank_mask:0xf
  v_and_b32_dpp v38, v29, v34 row_newbcast:6 row_mask:0xf bank_mask:0xf
  v_and_b32_dpp v39, v29, v35 row_newbcast:6 row_mask:0xf bank_mask:0xf
  v_mfma_f32_16x16x32_bf16 v[44:47], v[40:43], v[152:155], v[44:47]
  s_nop 0
  v_mfma_f32_16x16x32_bf16 v[44:47], v[36:39], v[230:233], v[44:47]
  v_and_b32_dpp v36, v16, v32 row_newbcast:14 row_mask:0xf bank_mask:0xf
  v_and_b32_dpp v37, v16, v33 row_newbcast:14 row_mask:0xf bank_mask:0xf
  v_and_b32_dpp v38, v16, v34 row_newbcast:14 row_mask:0xf bank_mask:0xf
  v_and_b32_dpp v39, v16, v35 row_newbcast:14 row_mask:0xf bank_mask:0xf
  s_sub_u32 s84, s91, s84
  s_cmp_lt_u32 s84, 2500
  s_cselect_b32 s84, s84, 0
  s_add_u32 s80, s80, s84
  s_sub_u32 s85, s91, s85
  s_cmp_lt_u32 s85, 2500
  s_cselect_b32 s85, s85, 0
  s_add_u32 s80, s80, s85
  s_cmp_lg_u32 s90, 0
  v_and_b32_dpp v40, v17, v32 row_newbcast:14 row_mask:0xf bank_mask:0xf
  v_and_b32_dpp v41, v17, v33 row_newbcast:14 row_mask:0xf bank_mask:0xf
  v_and_b32_dpp v42, v17, v34 row_newbcast:14 row_mask:0xf bank_mask:0xf
  v_and_b32_dpp v43, v17, v35 row_newbcast:14 row_mask:0xf bank_mask:0xf
  v_mfma_f32_16x16x32_bf16 v[44:47], v[36:39], v[92:95], v[44:47]
  s_cbranch_vccnz L_pxa11
  s_cbranch_scc1 L_pxb11
  s_waitcnt vmcnt(3)
L_pxb11:
  s_waitcnt vmcnt(4)
L_pxa11:
  s_cbranch_scc1 L_pxc11
  s_waitcnt vmcnt(5)
L_pxc11:
  s_waitcnt vmcnt(9)
  buffer_load_dwordx4 v[92:95], v3, s[16:19], s38 offen offset:3072 nt
  v_and_b32_dpp v36, v29, v32 row_newbcast:14 row_mask:0xf bank_mask:0xf
  v_and_b32_dpp v37, v29, v33 row_newbcast:14 row_mask:0xf bank_mask:0xf
  v_and_b32_dpp v38, v29, v34 row_newbcast:14 row_mask:0xf bank_mask:0xf
  v_and_b32_dpp v39, v29, v35 row_newbcast:14 row_mask:0xf bank_mask:0xf
  v_mfma_f32_16x16x32_bf16 v[44:47], v[40:43], v[156:159], v[44:47]
  s_nop 0
  v_mfma_f32_16x16x32_bf16 v[44:47], v[36:39], v[234:237], v[44:47]
  v_and_b32_dpp v36, v16, v32 row_newbcast:3 row_mask:0xf bank_mask:0xf
  v_and_b32_dpp v37, v16, v33 row_newbcast:3 row_mask:0xf bank_mask:0xf
  v_and_b32_dpp v38, v16, v34 row_newbcast:3 row_mask:0xf bank_mask:0xf
  v_and_b32_dpp v39, v16, v35 row_newbcast:3 row_mask:0xf bank_mask:0xf
  s_sub_u32 s86, s91, s86
  s_cmp_lt_u32 s86, 2500
  s_cselect_b32 s86, s86, 0
  s_add_u32 s80, s80, s86
  s_sub_u32 s87, s91, s87
  s_cmp_lt_u32 s87, 2500
  s_cselect_b32 s87, s87, 0
  s_add_u32 s80, s80, s87
  s_lshr_b32 s55, s80, 3
  s_sub_u32 s55, s91, s55
  s_cmp_lg_u32 s90, 0
  v_and_b32_dpp v40, v17, v32 row_newbcast:3 row_mask:0xf bank_mask:0xf
  v_and_b32_dpp v41, v17, v33 row_newbcast:3 row_mask:0xf bank_mask:0xf
  v_and_b32_dpp v42, v17, v34 row_newbcast:3 row_mask:0xf bank_mask:0xf
  v_and_b32_dpp v43, v17, v35 row_newbcast:3 row_mask:0xf bank_mask:0xf
  v_mfma_f32_16x16x32_bf16 v[44:47], v[36:39], v[96:99], v[44:47]
  s_cbranch_vccnz L_pxa12
  s_cbranch_scc1 L_pxb12
  s_waitcnt vmcnt(3)
L_pxb12:
  s_waitcnt vmcnt(4)
L_pxa12:
  s_cbranch_scc1 L_pxc12
  s_waitcnt vmcnt(5)
L_pxc12:
  s_waitcnt vmcnt(9)
  buffer_load_dwordx4 v[96:99], v3, s[16:19], s39 offen offset:0 nt
  v_and_b32_dpp v36, v29, v32 row_newbcast:3 row_mask:0xf bank_mask:0xf
  v_and_b32_dpp v37, v29, v33 row_newbcast:3 row_mask:0xf bank_mask:0xf
  v_and_b32_dpp v38, v29, v34 row_newbcast:3 row_mask:0xf bank_mask:0xf
  v_and_b32_dpp v39, v29, v35 row_newbcast:3 row_mask:0xf bank_mask:0xf
  v_mfma_f32_16x16x32_bf16 v[44:47], v[40:43], v[160:163], v[44:47]
  s_nop 0
  v_mfma_f32_16x16x32_bf16 v[44:47], v[36:39], v[238:241], v[44:47]
  v_and_b32_dpp v36, v16, v32 row_newbcast:11 row_mask:0xf bank_mask:0xf
  v_and_b32_dpp v37, v16, v33 row_newbcast:11 row_mask:0xf bank_mask:0xf
  v_and_b32_dpp v38, v16, v34 row_newbcast:11 row_mask:0xf bank_mask:0xf
  v_and_b32_dpp v39, v16, v35 row_newbcast:11 row_mask:0xf bank_mask:0xf
  s_sub_u32 s91, s55, s57
  s_add_u32 s49, s92, 3
  s_min_u32 s91, s91, s49
  s_sub_u32 s49, s92, 3
  s_max_u32 s91, s91, s49
  s_cmp_ge_u32 s48, 1280
  s_cselect_b32 s92, s91, s92
  s_mul_i32 s91, s92, 2
  s_cmp_lg_u32 s90, 0
  v_and_b32_dpp v40, v17, v32 row_newbcast:11 row_mask:0xf bank_mask:0xf
  v_and_b32_dpp v41, v17, v33 row_newbcast:11 row_mask:0xf bank_mask:0xf
  v_and_b32_dpp v42, v17, v34 row_newbcast:11 row_mask:0xf bank_mask:0xf
  v_and_b32_dpp v43, v17, v35 row_newbcast:11 row_mask:0xf bank_mask:0xf
  v_mfma_f32_16x16x32_bf16 v[44:47], v[36:39], v[100:103], v[44:47]
  s_cbranch_vccnz L_pxa13
  s_cbranch_scc1 L_pxb13
  s_waitcnt vmcnt(3)
L_pxb13:
  s_waitcnt vmcnt(4)
L_pxa13:
  s_cbranch_scc1 L_pxc13
  s_waitcnt vmcnt(5)
L_pxc13:
  s_waitcnt vmcnt(9)
  buffer_load_dwordx4 v[100:103], v3, s[16:19], s39 offen offset:1024 nt
  v_and_b32_dpp v36, v29, v32 row_newbcast:11 row_mask:0xf bank_mask:0xf
  v_and_b32_dpp v37, v29, v33 row_newbcast:11 row_mask:0xf bank_mask:0xf
  v_and_b32_dpp v38, v29, v34 row_newbcast:11 row_mask:0xf bank_mask:0xf
  v_and_b32_dpp v39, v29, v35 row_newbcast:11 row_mask:0xf bank_mask:0xf
  v_mfma_f32_16x16x32_bf16 v[44:47], v[40:43], v[164:167], v[44:47]
  s_nop 0
  v_mfma_f32_16x16x32_bf16 v[44:47], v[36:39], v[242:245], v[44:47]
  v_and_b32_dpp v36, v16, v32 row_newbcast:7 row_mask:0xf bank_mask:0xf
  v_and_b32_dpp v37, v16, v33 row_newbcast:7 row_mask:0xf bank_mask:0xf
  v_and_b32_dpp v38, v16, v34 row_newbcast:7 row_mask:0xf bank_mask:0xf
  v_and_b32_dpp v39, v16, v35 row_newbcast:7 row_mask:0xf bank_mask:0xf
  s_lshr_b32 s91, s91, 2
  s_add_u32 s49, s55, s91
  s_mov_b32 s57, s56
  s_mov_b32 s56, s53
  s_mov_b32 s53, s52
  s_mov_b32 s52, s55
  s_cmp_lg_u32 s90, 0
  v_and_b32_dpp v40, v17, v32 row_newbcast:7 row_mask:0xf bank_mask:0xf
  v_and_b32_dpp v41, v17, v33 row_newbcast:7 row_mask:0xf bank_mask:0xf
  v_and_b32_dpp v42, v17, v34 row_newbcast:7 row_mask:0xf bank_mask:0xf
  v_and_b32_dpp v43, v17, v35 row_newbcast:7 row_mask:0xf bank_mask:0xf
  v_mfma_f32_16x16x32_bf16 v[44:47], v[36:39], v[104:107], v[44:47]
  s_cbranch_vccnz L_pxa14
  s_cbranch_scc1 L_pxb14
  s_waitcnt vmcnt(3)
L_pxb14:
  s_waitcnt vmcnt(4)
L_pxa14:
  s_cbranch_scc1 L_pxc14
  s_waitcnt vmcnt(5)
L_pxc14:
  s_waitcnt vmcnt(9)
  buffer_load_dwordx4 v[104:107], v3, s[16:19], s39 offen offset:2048 nt
  v_and_b32_dpp v36, v29, v32 row_newbcast:7 row_mask:0xf bank_mask:0xf
  v_and_b32_dpp v37, v29, v33 row_newbcast:7 row_mask:0xf bank_mask:0xf
  v_and_b32_dpp v38, v29, v34 row_newbcast:7 row_mask:0xf bank_mask:0xf
  v_and_b32_dpp v39, v29, v35 row_newbcast:7 row_mask:0xf bank_mask:0xf
  v_mfma_f32_16x16x32_bf16 v[44:47], v[40:43], v[168:171], v[44:47]
  s_nop 0
  v_mfma_f32_16x16x32_bf16 v[44:47], v[36:39], v[246:249], v[44:47]
  v_and_b32_dpp v36, v16, v32 row_newbcast:15 row_mask:0xf bank_mask:0xf
  v_and_b32_dpp v37, v16, v33 row_newbcast:15 row_mask:0xf bank_mask:0xf
  v_and_b32_dpp v38, v16, v34 row_newbcast:15 row_mask:0xf bank_mask:0xf
  v_and_b32_dpp v39, v16, v35 row_newbcast:15 row_mask:0xf bank_mask:0xf
  s_add_u32 s91, s50, 0x40000000
  s_cmp_lt_u32 s48, 128
  s_cselect_b32 s49, s91, s49
  s_add_u32 s48, s48, 128
  s_memrealtime s[50:51]
  s_cmp_lg_u32 s90, 0
  v_and_b32_dpp v40, v17, v32 row_newbcast:15 row_mask:0xf bank_mask:0xf
  v_and_b32_dpp v41, v17, v33 row_newbcast:15 row_mask:0xf bank_mask:0xf
  v_and_b32_dpp v42, v17, v34 row_newbcast:15 row_mask:0xf bank_mask:0xf
  v_and_b32_dpp v43, v17, v35 row_newbcast:15 row_mask:0xf bank_mask:0xf
  v_mfma_f32_16x16x32_bf16 v[44:47], v[36:39], v[108:111], v[44:47]
  s_cbranch_vccnz L_pxa15
  s_cbranch_scc1 L_pxb15
  s_waitcnt vmcnt(3)
L_pxb15:
  s_waitcnt vmcnt(4)
L_pxa15:
  s_cbranch_scc1 L_pxc15
  s_waitcnt vmcnt(5)
L_pxc15:
  s_waitcnt vmcnt(9)
  buffer_load_dwordx4 v[108:111], v3, s[16:19], s39 offen offset:3072 nt
  v_and_b32_dpp v36, v29, v32 row_newbcast:15 row_mask:0xf bank_mask:0xf
  v_and_b32_dpp v37, v29, v33 row_newbcast:15 row_mask:0xf bank_mask:0xf
  v_and_b32_dpp v38, v29, v34 row_newbcast:15 row_mask:0xf bank_mask:0xf
  v_and_b32_dpp v39, v29, v35 row_newbcast:15 row_mask:0xf bank_mask:0xf
  v_mfma_f32_16x16x32_bf16 v[44:47], v[40:43], v[172:175], v[44:47]
  s_nop 0
  v_mfma_f32_16x16x32_bf16 v[44:47], v[36:39], v[250:253], v[44:47]
  v_and_b32_dpp v36, v18, v32 row_newbcast:0 row_mask:0xf bank_mask:0xf
  v_and_b32_dpp v37, v18, v33 row_newbcast:0 row_mask:0xf bank_mask:0xf
  v_and_b32_dpp v38, v18, v34 row_newbcast:0 row_mask:0xf bank_mask:0xf
  v_and_b32_dpp v39, v18, v35 row_newbcast:0 row_mask:0xf bank_mask:0xf
  s_mov_b32 s34, 10
  s_mov_b32 s4, -20
  s_mov_b32 s5, 50
L_vloop:
  s_add_u32 s29, s29, 1
  s_bfe_u32 s35, s29, 65536
  s_lshl_b32 s35, s35, 15
  s_bfe_u32 s3, s29, 131073
  s_lshl_b32 s3, s3, 17
  s_or_b32 s35, s35, s3
  s_bfe_u32 s3, s29, 65539
  s_lshl_b32 s3, s3, 12
  s_or_b32 s35, s35, s3
  v_xor_b32 v3, s35, v189
  s_waitcnt lgkmcnt(0)
  s_sub_u32 s79, s50, s49
  s_add_u32 s93, s79, 1500
  s_cmp_lt_u32 s93, 3000
  s_cselect_b32 s79, s79, -20
  s_cmp_ge_i32 s79, 18
  s_cselect_b64 vcc, -1, 0
  s_cselect_b32 s93, s5, s4
  s_cmp_ge_i32 s79, s93
  s_cselect_b32 s90, 1, 0
  v_mfma_f32_16x16x32_bf16 v[44:47], v[36:39], v[48:51], v[44:47]
  s_cbranch_vccnz L_pva0
  s_cbranch_scc1 L_pvb0
  s_waitcnt vmcnt(3)
L_pvb0:
  s_waitcnt vmcnt(4)
L_pva0:
  s_cbranch_scc1 L_pvc0
  s_waitcnt vmcnt(5)
L_pvc0:
  s_waitcnt vmcnt(9)
  buffer_load_dwordx4 v[48:51], v3, s[16:19], 0 offen offset:0 nt
  v_and_b32_dpp v40, v18, v32 row_newbcast:8 row_mask:0xf bank_mask:0xf
  v_and_b32_dpp v41, v18, v33 row_newbcast:8 row_mask:0xf bank_mask:0xf
  v_and_b32_dpp v42, v18, v34 row_newbcast:8 row_mask:0xf bank_mask:0xf
  v_and_b32_dpp v43, v18, v35 row_newbcast:8 row_mask:0xf bank_mask:0xf
  v_mov_b32 v17, v19
  s_and_b32 s93, s48, 384
  s_cmp_lg_u32 s54, s93
  s_cbranch_scc1 L_ck7_nopub
  v_mov_b32 v187, s50
  s_mov_b64 exec, 1
  buffer_store_dword v187, off, s[20:23], s48 sc1
  s_mov_b64 exec, -1
L_ck7_nopub:
  s_cmp_lg_u32 s90, 0
  v_mfma_f32_16x16x32_bf16 v[44:47], v[40:43], v[52:55], v[44:47]
  s_cbranch_vccnz L_pva1
  s_cbranch_scc1 L_pvb1
  s_waitcnt vmcnt(3)
L_pvb1:
  s_waitcnt vmcnt(4)
L_pva1:
  s_cbranch_scc1 L_pvc1
  s_waitcnt vmcnt(5)
L_pvc1:
  s_waitcnt vmcnt(9)
  buffer_load_dwordx4 v[52:55], v3, s[16:19], 0 offen offset:1024 nt
  v_and_b32_dpp v36, v18, v32 row_newbcast:4 row_mask:0xf bank_mask:0xf
  v_and_b32_dpp v37, v18, v33 row_newbcast:4 row_mask:0xf bank_mask:0xf
  v_and_b32_dpp v38, v18, v34 row_newbcast:4 row_mask:0xf bank_mask:0xf
  v_and_b32_dpp v39, v18, v35 row_newbcast:4 row_mask:0xf bank_mask:0xf
  v_mov_b32 v19, v20
  s_nop 0
  v_mfma_f32_16x16x32_bf16 v[44:47], v[36:39], v[56:59], v[44:47]
  s_cbranch_vccnz L_pva2
  s_cbranch_scc1 L_pvb2
  s_waitcnt vmcnt(3)
L_pvb2:
  s_waitcnt vmcnt(4)
L_pva2:
  s_cbranch_scc1 L_pvc2
  s_waitcnt vmcnt(5)
L_pvc2:
  s_waitcnt vmcnt(9)
  buffer_load_dwordx4 v[56:59], v3, s[16:19], 0 offen offset:2048 nt
  v_and_b32_dpp v40, v18, v32 row_newbcast:12 row_mask:0xf bank_mask:0xf
  v_and_b32_dpp v41, v18, v33 row_newbcast:12 row_mask:0xf bank_mask:0xf
  v_and_b32_dpp v42, v18, v34 row_newbcast:12 row_mask:0xf bank_mask:0xf
  v_and_b32_dpp v43, v18, v35 row_newbcast:12 row_mask:0xf bank_mask:0xf
  v_mov_b32 v20, v21
  s_memrealtime s[98:99]
  s_lshr_b32 s93, s92, 4
  s_add_u32 s49, s49, s93
  s_cmp_lg_u32 s90, 0
  v_mfma_f32_16x16x32_bf16 v[44:47], v[40:43], v[60:63], v[44:47]
  s_cbranch_vccnz L_pva3
  s_cbranch_scc1 L_pvb3
  s_waitcnt vmcnt(3)
L_pvb3:
  s_waitcnt vmcnt(4)
L_pva3:
  s_cbranch_scc1 L_pvc3
  s_waitcnt vmcnt(5)
L_pvc3:
  s_waitcnt vmcnt(9)
  buffer_load_dwordx4 v[60:63], v3, s[16:19], 0 offen offset:3072 nt
  v_and_b32_dpp v36, v18, v32 row_newbcast:1 row_mask:0xf bank_mask:0xf
  v_and_b32_dpp v37, v18, v33 row_newbcast:1 row_mask:0xf bank_mask:0xf
  v_and_b32_dpp v38, v18, v34 row_newbcast:1 row_mask:0xf bank_mask:0xf
  v_and_b32_dpp v39, v18, v35 row_newbcast:1 row_mask:0xf bank_mask:0xf
  v_mov_b32 v21, v22
  s_waitcnt lgkmcnt(0)
  s_sub_u32 s79, s98, s49
  s_add_u32 s93, s79, 1500
  s_cmp_lt_u32 s93, 3000
  s_cselect_b32 s79, s79, -20
  s_cmp_ge_i32 s79, 18
  s_cselect_b64 vcc, -1, 0
  s_cselect_b32 s93, s5, s4
  s_cmp_ge_i32 s79, s93
  s_cselect_b32 s90, 1, 0
  s_cmp_lg_u32 s90, 0
  v_mfma_f32_16x16x32_bf16 v[44:47], v[36:39], v[64:67], v[44:47]
  s_cbranch_vccnz L_pva4
  s_cbranch_scc1 L_pvb4
  s_waitcnt vmcnt(3)
L_pvb4:
  s_waitcnt vmcnt(4)
L_pva4:
  s_cbranch_scc1 L_pvc4
  s_waitcnt vmcnt(5)
L_pvc4:
  s_waitcnt vmcnt(9)
  buffer_load_dwordx4 v[64:67], v3, s[16:19], s37 offen offset:0 nt
  v_and_b32_dpp v40, v18, v32 row_newbcast:9 row_mask:0xf bank_mask:0xf
  v_and_b32_dpp v41, v18, v33 row_newbcast:9 row_mask:0xf bank_mask:0xf
  v_and_b32_dpp v42, v18, v34 row_newbcast:9 row_mask:0xf bank_mask:0xf
  v_and_b32_dpp v43, v18, v35 row_newbcast:9 row_mask:0xf bank_mask:0xf
  v_mov_b32 v22, v23
  s_add_u32 s88, s46, s48
  s_addc_u32 s89, s47, 0
  s_cmp_lt_u32 s48, 128
  s_cbranch_scc1 L_ck7_early
  s_load_dword s80, s[88:89], 0
  s_load_dword s81, s[88:89], 5120
  s_load_dword s82, s[88:89], 10240
  s_load_dword s83, s[88:89], 15360
  s_load_dword s84, s[88:89], 20480
  s_load_dword s85, s[88:89], 25600
  s_load_dword s86, s[88:89], 30720
  s_load_dword s87, s[88:89], 35840
L_ck7_early:
  s_cmp_lg_u32 s90, 0
  v_mfma_f32_16x16x32_bf16 v[44:47], v[40:43], v[68:71], v[44:47]
  s_cbranch_vccnz L_pva5
  s_cbranch_scc1 L_pvb5
  s_waitcnt vmcnt(3)
L_pvb5:
  s_waitcnt vmcnt(4)
L_pva5:
  s_cbranch_scc1 L_pvc5
  s_waitcnt vmcnt(5)
L_pvc5:
  s_waitcnt vmcnt(9)
  buffer_load_dwordx4 v[68:71], v3, s[16:19], s37 offen offset:1024 nt
  v_and_b32_dpp v36, v18, v32 row_newbcast:5 row_mask:0xf bank_mask:0xf
  v_and_b32_dpp v37, v18, v33 row_newbcast:5 row_mask:0xf bank_mask:0xf
  v_and_b32_dpp v38, v18, v34 row_newbcast:5 row_mask:0xf bank_mask:0xf
  v_and_b32_dpp v39, v18, v35 row_newbcast:5 row_mask:0xf bank_mask:0xf
  v_mov_b32 v23, v24
  s_nop 0
  v_mfma_f32_16x16x32_bf16 v[44:47], v[36:39], v[72:75], v[44:47]
  s_cbranch_vccnz L_pva6
  s_cbranch_scc1 L_pvb6
  s_waitcnt vmcnt(3)
L_pvb6:
  s_waitcnt vmcnt(4)
L_pva6:
  s_cbranch_scc1 L_pvc6
  s_waitcnt vmcnt(5)
L_pvc6:
  s_waitcnt vmcnt(9)
  buffer_load_dwordx4 v[72:75], v3, s[16:19], s37 offen offset:2048 nt
  v_and_b32_dpp v40, v18, v32 row_newbcast:13 row_mask:0xf bank_mask:0xf
  v_and_b32_dpp v41, v18, v33 row_newbcast:13 row_mask:0xf bank_mask:0xf
  v_and_b32_dpp v42, v18, v34 row_newbcast:13 row_mask:0xf bank_mask:0xf
  v_and_b32_dpp v43, v18, v35 row_newbcast:13 row_mask:0xf bank_mask:0xf
  v_mov_b32 v24, v25
  s_memrealtime s[98:99]
  s_lshr_b32 s93, s92, 4
  s_add_u32 s49, s49, s93
  s_cmp_lg_u32 s90, 0
  v_mfma_f32_16x16x32_bf16 v[44:47], v[40:43], v[76:79], v[44:47]
  s_cbranch_vccnz L_pva7
  s_cbranch_scc1 L_pvb7
  s_waitcnt vmcnt(3)
L_pvb7:
  s_waitcnt vmcnt(4)
L_pva7:
  s_cbranch_scc1 L_pvc7
  s_waitcnt vmcnt(5)
L_pvc7:
  s_waitcnt vmcnt(9)
  buffer_load_dwordx4 v[76:79], v3, s[16:19], s37 offen offset:3072 nt
  v_and_b32_dpp v36, v18, v32 row_newbcast:2 row_mask:0xf bank_mask:0xf
  v_and_b32_dpp v37, v18, v33 row_newbcast:2 row_mask:0xf bank_mask:0xf
  v_and_b32_dpp v38, v18, v34 row_newbcast:2 row_mask:0xf bank_mask:0xf
  v_and_b32_dpp v39, v18, v35 row_newbcast:2 row_mask:0xf bank_mask:0xf
  v_mov_b32 v25, v26
  s_waitcnt lgkmcnt(0)
  s_sub_u32 s79, s98, s49
  s_add_u32 s93, s79, 1500
  s_cmp_lt_u32 s93, 3000
  s_cselect_b32 s79, s79, -20
  s_cmp_ge_i32 s79, 18
  s_cselect_b64 vcc, -1, 0
  s_cselect_b32 s93, s5, s4
  s_cmp_ge_i32 s79, s93
  s_cselect_b32 s90, 1, 0
  s_cmp_lg_u32 s90, 0
  v_mfma_f32_16x16x32_bf16 v[44:47], v[36:39], v[80:83], v[44:47]
  s_cbranch_vccnz L_pva8
  s_cbranch_scc1 L_pvb8
  s_waitcnt vmcnt(3)
L_pvb8:
  s_waitcnt vmcnt(4)
L_pva8:
  s_cbranch_scc1 L_pvc8
  s_waitcnt vmcnt(5)
L_pvc8:
  s_waitcnt vmcnt(9)
  buffer_load_dwordx4 v[80:83], v3, s[16:19], s38 offen offset:0 nt
  v_and_b32_dpp v40, v18, v32 row_newbcast:10 row_mask:0xf bank_mask:0xf
  v_and_b32_dpp v41, v18, v33 row_newbcast:10 row_mask:0xf bank_mask:0xf
  v_and_b32_dpp v42, v18, v34 row_newbcast:10 row_mask:0xf bank_mask:0xf
  v_and_b32_dpp v43, v18, v35 row_newbcast:10 row_mask:0xf bank_mask:0xf
  v_mov_b32 v26, v27
  s_add_u32 s91, s50, 64
  s_sub_u32 s80, s91, s80
  s_cmp_lt_u32 s80, 2500
  s_cselect_b32 s80, s80, 0
  s_sub_u32 s81, s91, s81
  s_cmp_lt_u32 s81, 2500
  s_cselect_b32 s81, s81, 0
  s_add_u32 s80, s80, s81
  s_cmp_lg_u32 s90, 0
  v_mfma_f32_16x16x32_bf16 v[44:47], v[40:43], v[84:87], v[44:47]
  s_cbranch_vccnz L_pva9
  s_cbranch_scc1 L_pvb9
  s_waitcnt vmcnt(3)
L_pvb9:
  s_waitcnt vmcnt(4)
L_pva9:
  s_cbranch_scc1 L_pvc9
  s_waitcnt vmcnt(5)
L_pvc9:
  s_waitcnt vmcnt(9)
  buffer_load_dwordx4 v[84:87], v3, s[16:19], s38 offen offset:1024 nt
  v_and_b32_dpp v36, v18, v32 row_newbcast:6 row_mask:0xf bank_mask:0xf
  v_and_b32_dpp v37, v18, v33 row_newbcast:6 row_mask:0xf bank_mask:0xf
  v_and_b32_dpp v38, v18, v34 row_newbcast:6 row_mask:0xf bank_mask:0xf
  v_and_b32_dpp v39, v18, v35 row_newbcast:6 row_mask:0xf bank_mask:0xf
  v_mov_b32 v27, v28
  s_sub_u32 s82, s91, s82
  s_cmp_lt_u32 s82, 2500
  s_cselect_b32 s82, s82, 0
  s_add_u32 s80, s80, s82
  s_sub_u32 s83, s91, s83
  s_cmp_lt_u32 s83, 2500
  s_cselect_b32 s83, s83, 0
  s_add_u32 s80, s80, s83
  s_cmp_lg_u32 s90, 0
  v_mfma_f32_16x16x32_bf16 v[44:47], v[36:39], v[88:91], v[44:47]
  s_cbranch_vccnz L_pva10
  s_cbranch_scc1 L_pvb10
  s_waitcnt vmcnt(3)
L_pvb10:
  s_waitcnt vmcnt(4)
L_pva10:
  s_cbranch_scc1 L_pvc10
  s_waitcnt vmcnt(5)
L_pvc10:
  s_waitcnt vmcnt(9)
  buffer_load_dwordx4 v[88:91], v3, s[16:19], s38 offen offset:2048 nt
  v_and_b32_dpp v40, v18, v32 row_newbcast:14 row_mask:0xf bank_mask:0xf
  v_and_b32_dpp v41, v18, v33 row_newbcast:14 row_mask:0xf bank_mask:0xf
  v_and_b32_dpp v42, v18, v34 row_newbcast:14 row_mask:0xf bank_mask:0xf
  v_and_b32_dpp v43, v18, v35 row_newbcast:14 row_mask:0xf bank_mask:0xf
  v_mov_b32 v28, v29
  s_memrealtime s[98:99]
  s_lshr_b32 s93, s92, 4
  s_add_u32 s49, s49, s93
  s_sub_u32 s84, s91, s84
  s_cmp_lt_u32 s84, 2500
  s_cselect_b32 s84, s84, 0
  s_add_u32 s80, s80, s84
  s_sub_u32 s85, s91, s85
  s_cmp_lt_u32 s85, 2500
  s_cselect_b32 s85, s85, 0
  s_add_u32 s80, s80, s85
  s_cmp_lg_u32 s90, 0
  v_mfma_f32_16x16x32_bf16 v[44:47], v[40:43], v[92:95], v[44:47]
  s_cbranch_vccnz L_pva11
  s_cbranch_scc1 L_pvb11
  s_waitcnt vmcnt(3)
L_pvb11:
  s_waitcnt vmcnt(4)
L_pva11:
  s_cbranch_scc1 L_pvc11
  s_waitcnt vmcnt(5)
L_pvc11:
  s_waitcnt vmcnt(9)
  buffer_load_dwordx4 v[92:95], v3, s[16:19], s38 offen offset:3072 nt
  v_and_b32_dpp v36, v18, v32 row_newbcast:3 row_mask:0xf bank_mask:0xf
  v_and_b32_dpp v37, v18, v33 row_newbcast:3 row_mask:0xf bank_mask:0xf
  v_and_b32_dpp v38, v18, v34 row_newbcast:3 row_mask:0xf bank_mask:0xf
  v_and_b32_dpp v39, v18, v35 row_newbcast:3 row_mask:0xf bank_mask:0xf
  s_waitcnt lgkmcnt(0)
  s_sub_u32 s79, s98, s49
  s_add_u32 s93, s79, 1500
  s_cmp_lt_u32 s93, 3000
  s_cselect_b32 s79, s79, -20
  s_cmp_ge_i32 s79, 18
  s_cselect_b64 vcc, -1, 0
  s_cselect_b32 s93, s5, s4
  s_cmp_ge_i32 s79, s93
  s_cselect_b32 s90, 1, 0
  s_sub_u32 s86, s91, s86
  s_cmp_lt_u32 s86, 2500
  s_cselect_b32 s86, s86, 0
  s_add_u32 s80, s80, s86
  s_sub_u32 s87, s91, s87
  s_cmp_lt_u32 s87, 2500
  s_cselect_b32 s87, s87, 0
  s_add_u32 s80, s80, s87
  s_lshr_b32 s55, s80, 3
  s_sub_u32 s55, s91, s55
  s_cmp_lg_u32 s90, 0
  v_mfma_f32_16x16x32_bf16 v[44:47], v[36:39], v[96:99], v[44:47]
  s_cbranch_vccnz L_pva12
  s_cbranch_scc1 L_pvb12
  s_waitcnt vmcnt(3)
L_pvb12:
  s_waitcnt vmcnt(4)
L_pva12:
  s_cbranch_scc1 L_pvc12
  s_waitcnt vmcnt(5)
L_pvc12:
  s_waitcnt vmcnt(9)
  buffer_load_dwordx4 v[96:99], v3, s[16:19], s39 offen offset:0 nt
  v_and_b32_dpp v40, v18, v32 row_newbcast:11 row_mask:0xf bank_mask:0xf
  v_and_b32_dpp v41, v18, v33 row_newbcast:11 row_mask:0xf bank_mask:0xf
  v_and_b32_dpp v42, v18, v34 row_newbcast:11 row_mask:0xf bank_mask:0xf
  v_and_b32_dpp v43, v18, v35 row_newbcast:11 row_mask:0xf bank_mask:0xf
  s_sub_u32 s91, s55, s57
  s_add_u32 s49, s92, 3
  s_min_u32 s91, s91, s49
  s_sub_u32 s49, s92, 3
  s_max_u32 s91, s91, s49
  s_cmp_ge_u32 s48, 1280
  s_cselect_b32 s92, s91, s92
  s_mul_i32 s91, s92, 2
  s_cmp_lg_u32 s90, 0
  v_mfma_f32_16x16x32_bf16 v[44:47], v[40:43], v[100:103], v[44:47]
  s_cbranch_vccnz L_pva13
  s_cbranch_scc1 L_pvb13
  s_waitcnt vmcnt(3)
L_pvb13:
  s_waitcnt vmcnt(4)
L_pva13:
  s_cbranch_scc1 L_pvc13
  s_waitcnt vmcnt(5)
L_pvc13:
  s_waitcnt vmcnt(9)
  buffer_load_dwordx4 v[100:103], v3, s[16:19], s39 offen offset:1024 nt
  v_and_b32_dpp v36, v18, v32 row_newbcast:7 row_mask:0xf bank_mask:0xf
  v_and_b32_dpp v37, v18, v33 row_newbcast:7 row_mask:0xf bank_mask:0xf
  v_and_b32_dpp v38, v18, v34 row_newbcast:7 row_mask:0xf bank_mask:0xf
  v_and_b32_dpp v39, v18, v35 row_newbcast:7 row_mask:0xf bank_mask:0xf
  s_lshr_b32 s91, s91, 2
  s_add_u32 s49, s55, s91
  s_mov_b32 s57, s56
  s_mov_b32 s56, s53
  s_mov_b32 s53, s52
  s_mov_b32 s52, s55
  s_cmp_lg_u32 s90, 0
  v_mfma_f32_16x16x32_bf16 v[44:47], v[36:39], v[104:107], v[44:47]
  s_cbranch_vccnz L_pva14
  s_cbranch_scc1 L_pvb14
  s_waitcnt vmcnt(3)
L_pvb14:
  s_waitcnt vmcnt(4)
L_pva14:
  s_cbranch_scc1 L_pvc14
  s_waitcnt vmcnt(5)
L_pvc14:
  s_waitcnt vmcnt(9)
  buffer_load_dwordx4 v[104:107], v3, s[16:19], s39 offen offset:2048 nt
  v_and_b32_dpp v40, v18, v32 row_newbcast:15 row_mask:0xf bank_mask:0xf
  v_and_b32_dpp v41, v18, v33 row_newbcast:15 row_mask:0xf bank_mask:0xf
  v_and_b32_dpp v42, v18, v34 row_newbcast:15 row_mask:0xf bank_mask:0xf
  v_and_b32_dpp v43, v18, v35 row_newbcast:15 row_mask:0xf bank_mask:0xf
  s_add_u32 s91, s50, 0x40000000
  s_cmp_lt_u32 s48, 128
  s_cselect_b32 s49, s91, s49
  s_add_u32 s48, s48, 128
  s_memrealtime s[50:51]
  s_cmp_lg_u32 s90, 0
  v_mfma_f32_16x16x32_bf16 v[44:47], v[40:43], v[108:111], v[44:47]
  s_cbranch_vccnz L_pva15
  s_cbranch_scc1 L_pvb15
  s_waitcnt vmcnt(3)
L_pvb15:
  s_waitcnt vmcnt(4)
L_pva15:
  s_cbranch_scc1 L_pvc15
  s_waitcnt vmcnt(5)
L_pvc15:
  s_waitcnt vmcnt(9)
  buffer_load_dwordx4 v[108:111], v3, s[16:19], s39 offen offset:3072 nt
  v_and_b32_dpp v36, v17, v32 row_newbcast:0 row_mask:0xf bank_mask:0xf
  v_and_b32_dpp v37, v17, v33 row_newbcast:0 row_mask:0xf bank_mask:0xf
  v_and_b32_dpp v38, v17, v34 row_newbcast:0 row_mask:0xf bank_mask:0xf
  v_and_b32_dpp v39, v17, v35 row_newbcast:0 row_mask:0xf bank_mask:0xf
  v_mov_b32 v18, v17
  s_sub_u32 s34, s34, 1
  s_cmp_lg_u32 s34, 0
  s_cbranch_scc1 L_vloop
  v_lshl_add_u32 v176, v0, 3, v188
  s_call_b64 s[62:63], L_sub_pv
  s_nop 6
  ds_write_b64 v176, v[44:45] offset:0
  s_waitcnt lgkmcnt(0)
  s_barrier
  s_and_b32 s3, s78, 15
  s_lshl_b32 s33, s28, 5
  s_add_u32 s3, s3, s33
  s_cmp_ge_u32 s3, 9
  s_cbranch_scc1 L_end
  v_lshl_add_u32 v176, v2, 4, v188
  ds_read_b128 v[12:15], v176 offset:8960
  s_lshr_b32 s68, s2, 5
  s_mul_i32 s3, s68, 4608
  s_add_u32 s12, s60, s3
  s_addc_u32 s13, s61, 0
  s_mov_b32 s14, 1147392
  s_mov_b32 s15, 0x20000
  s_mov_b32 s16, s6
  s_mov_b32 s17, s7
  s_mov_b32 s18, 9216
  s_mov_b32 s19, 0x20000
  s_mov_b32 s65, 294912
  s_mov_b32 s66, 589824
  s_mov_b32 s67, 884736
  s_mul_i32 s68, s68, 1152
  s_barrier
  s_waitcnt lgkmcnt(0)
  s_call_b64 s[62:63], L_sub_final
  s_endpgm
L_sub_pv:
  v_and_b32_dpp v36, v18, v32 row_newbcast:0 row_mask:0xf bank_mask:0xf
  v_and_b32_dpp v37, v18, v33 row_newbcast:0 row_mask:0xf bank_mask:0xf
  v_and_b32_dpp v38, v18, v34 row_newbcast:0 row_mask:0xf bank_mask:0xf
  v_and_b32_dpp v39, v18, v35 row_newbcast:0 row_mask:0xf bank_mask:0xf
  v_and_b32_dpp v40, v18, v32 row_newbcast:8 row_mask:0xf bank_mask:0xf
  v_and_b32_dpp v41, v18, v33 row_newbcast:8 row_mask:0xf bank_mask:0xf
  v_and_b32_dpp v42, v18, v34 row_newbcast:8 row_mask:0xf bank_mask:0xf
  v_and_b32_dpp v43, v18, v35 row_newbcast:8 row_mask:0xf bank_mask:0xf
  v_mfma_f32_16x16x32_bf16 v[44:47], v[36:39], v[48:51], v[44:47]
  v_and_b32_dpp v36, v18, v32 row_newbcast:4 row_mask:0xf bank_mask:0xf
  v_and_b32_dpp v37, v18, v33 row_newbcast:4 row_mask:0xf bank_mask:0xf
  v_and_b32_dpp v38, v18, v34 row_newbcast:4 row_mask:0xf bank_mask:0xf
  v_and_b32_dpp v39, v18, v35 row_newbcast:4 row_mask:0xf bank_mask:0xf
  v_mfma_f32_16x16x32_bf16 v[44:47], v[40:43], v[52:55], v[44:47]
  v_and_b32_dpp v40, v18, v32 row_newbcast:12 row_mask:0xf bank_mask:0xf
  v_and_b32_dpp v41, v18, v33 row_newbcast:12 row_mask:0xf bank_mask:0xf
  v_and_b32_dpp v42, v18, v34 row_newbcast:12 row_mask:0xf bank_mask:0xf
  v_and_b32_dpp v43, v18, v35 row_newbcast:12 row_mask:0xf bank_mask:0xf
  v_mfma_f32_16x16x32_bf16 v[44:47], v[36:39], v[56:59], v[44:47]
  v_and_b32_dpp v36, v18, v32 row_newbcast:1 row_mask:0xf bank_mask:0xf
  v_and_b32_dpp v37, v18, v33 row_newbcast:1 row_mask:0xf bank_mask:0xf
  v_and_b32_dpp v38, v18, v34 row_newbcast:1 row_mask:0xf bank_mask:0xf
  v_and_b32_dpp v39, v18, v35 row_newbcast:1 row_mask:0xf bank_mask:0xf
  v_mfma_f32_16x16x32_bf16 v[44:47], v[40:43], v[60:63], v[44:47]
  v_and_b32_dpp v40, v18, v32 row_newbcast:9 row_mask:0xf bank_mask:0xf
  v_and_b32_dpp v41, v18, v33 row_newbcast:9 row_mask:0xf bank_mask:0xf
  v_and_b32_dpp v42, v18, v34 row_newbcast:9 row_mask:0xf bank_mask:0xf
  v_and_b32_dpp v43, v18, v35 row_newbcast:9 row_mask:0xf bank_mask:0xf
  v_mfma_f32_16x16x32_bf16 v[44:47], v[36:39], v[64:67], v[44:47]
  v_and_b32_dpp v36, v18, v32 row_newbcast:5 row_mask:0xf bank_mask:0xf
  v_and_b32_dpp v37, v18, v33 row_newbcast:5 row_mask:0xf bank_mask:0xf
  v_and_b32_dpp v38, v18, v34 row_newbcast:5 row_mask:0xf bank_mask:0xf
  v_and_b32_dpp v39, v18, v35 row_newbcast:5 row_mask:0xf bank_mask:0xf
  v_mfma_f32_16x16x32_bf16 v[44:47], v[40:43], v[68:71], v[44:47]
  v_and_b32_dpp v40, v18, v32 row_newbcast:13 row_mask:0xf bank_mask:0xf
  v_and_b32_dpp v41, v18, v33 row_newbcast:13 row_mask:0xf bank_mask:0xf
  v_and_b32_dpp v42, v18, v34 row_newbcast:13 row_mask:0xf bank_mask:0xf
  v_and_b32_dpp v43, v18, v35 row_newbcast:13 row_mask:0xf bank_mask:0xf
  s_waitcnt vmcnt(9)
  v_mfma_f32_16x16x32_bf16 v[44:47], v[36:39], v[72:75], v[44:47]
  v_and_b32_dpp v36, v18, v32 row_newbcast:2 row_mask:0xf bank_mask:0xf
  v_and_b32_dpp v37, v18, v33 row_newbcast:2 row_mask:0xf bank_mask:0xf
  v_and_b32_dpp v38, v18, v34 row_newbcast:2 row_mask:0xf bank_mask:0xf
  v_and_b32_dpp v39, v18, v35 row_newbcast:2 row_mask:0xf bank_mask:0xf
  s_waitcnt vmcnt(8)
  v_mfma_f32_16x16x32_bf16 v[44:47], v[40:43], v[76:79], v[44:47]
  v_and_b32_dpp v40, v18, v32 row_newbcast:10 row_mask:0xf bank_mask:0xf
  v_and_b32_dpp v41, v18, v33 row_newbcast:10 row_mask:0xf bank_mask:0xf
  v_and_b32_dpp v42, v18, v34 row_newbcast:10 row_mask:0xf bank_mask:0xf
  v_and_b32_dpp v43, v18, v35 row_newbcast:10 row_mask:0xf bank_mask:0xf
  s_waitcnt vmcnt(7)
  v_mfma_f32_16x16x32_bf16 v[44:47], v[36:39], v[80:83], v[44:47]
  v_and_b32_dpp v36, v18, v32 row_newbcast:6 row_mask:0xf bank_mask:0xf
  v_and_b32_dpp v37, v18, v33 row_newbcast:6 row_mask:0xf bank_mask:0xf
  v_and_b32_dpp v38, v18, v34 row_newbcast:6 row_mask:0xf bank_mask:0xf
  v_and_b32_dpp v39, v18, v35 row_newbcast:6 row_mask:0xf bank_mask:0xf
  s_waitcnt vmcnt(6)
  v_mfma_f32_16x16x32_bf16 v[44:47], v[40:43], v[84:87], v[44:47]
  v_and_b32_dpp v40, v18, v32 row_newbcast:14 row_mask:0xf bank_mask:0xf
  v_and_b32_dpp v41, v18, v33 row_newbcast:14 row_mask:0xf bank_mask:0xf
  v_and_b32_dpp v42, v18, v34 row_newbcast:14 row_mask:0xf bank_mask:0xf
  v_and_b32_dpp v43, v18, v35 row_newbcast:14 row_mask:0xf bank_mask:0xf
  s_waitcnt vmcnt(5)
  v_mfma_f32_16x16x32_bf16 v[44:47], v[36:39], v[88:91], v[44:47]
  v_and_b32_dpp v36, v18, v32 row_newbcast:3 row_mask:0xf bank_mask:0xf
  v_and_b32_dpp v37, v18, v33 row_newbcast:3 row_mask:0xf bank_mask:0xf
  v_and_b32_dpp v38, v18, v34 row_newbcast:3 row_mask:0xf bank_mask:0xf
  v_and_b32_dpp v39, v18, v35 row_newbcast:3 row_mask:0xf bank_mask:0xf
  s_waitcnt vmcnt(4)
  v_mfma_f32_16x16x32_bf16 v[44:47], v[40:43], v[92:95], v[44:47]
  v_and_b32_dpp v40, v18, v32 row_newbcast:11 row_mask:0xf bank_mask:0xf
  v_and_b32_dpp v41, v18, v33 row_newbcast:11 row_mask:0xf bank_mask:0xf
  v_and_b32_dpp v42, v18, v34 row_newbcast:11 row_mask:0xf bank_mask:0xf
  v_and_b32_dpp v43, v18, v35 row_newbcast:11 row_mask:0xf bank_mask:0xf
  s_waitcnt vmcnt(3)
  v_mfma_f32_16x16x32_bf16 v[44:47], v[36:39], v[96:99], v[44:47]
  v_and_b32_dpp v36, v18, v32 row_newbcast:7 row_mask:0xf bank_mask:0xf
  v_and_b32_dpp v37, v18, v33 row_newbcast:7 row_mask:0xf bank_mask:0xf
  v_and_b32_dpp v38, v18, v34 row_newbcast:7 row_mask:0xf bank_mask:0xf
  v_and_b32_dpp v39, v18, v35 row_newbcast:7 row_mask:0xf bank_mask:0xf
  s_waitcnt vmcnt(2)
  v_mfma_f32_16x16x32_bf16 v[44:47], v[40:43], v[100:103], v[44:47]
  v_and_b32_dpp v40, v18, v32 row_newbcast:15 row_mask:0xf bank_mask:0xf
  v_and_b32_dpp v41, v18, v33 row_newbcast:15 row_mask:0xf bank_mask:0xf
  v_and_b32_dpp v42, v18, v34 row_newbcast:15 row_mask:0xf bank_mask:0xf
  v_and_b32_dpp v43, v18, v35 row_newbcast:15 row_mask:0xf bank_mask:0xf
  s_waitcnt vmcnt(1)
  v_mfma_f32_16x16x32_bf16 v[44:47], v[36:39], v[104:107], v[44:47]
  s_waitcnt vmcnt(0)
  v_mfma_f32_16x16x32_bf16 v[44:47], v[40:43], v[108:111], v[44:47]
  s_setpc_b64 s[62:63]
  s_endpgm
L_code_end:
.section .rodata,"a"
.p2align 6
.amdhsa_kernel recurrent_scan__mha_block_cached__dense_activation_gelu__decode_kernel
  .amdhsa_next_free_vgpr 256
  .amdhsa_next_free_sgpr 100
  .amdhsa_accum_offset 256
  .amdhsa_group_segment_fixed_size 0
  .amdhsa_kernarg_size 104
  .amdhsa_user_sgpr_count 2
  .amdhsa_user_sgpr_kernarg_segment_ptr 1
  .amdhsa_system_sgpr_workgroup_id_x 1
  .amdhsa_float_denorm_mode_32 3
.end_amdhsa_kernel
```
